```python
import torch

def _softmax(x, axis=-1):
    return torch.softmax(x, dim=axis)
def _gelu(x):
    return torch.nn.functional.gelu(x, approximate="tanh")
def _silu(x):
    return torch.nn.functional.silu(x)
def _sigmoid(x):
    return torch.sigmoid(x)
def _layernorm(x, axis=-1, eps=1e-5):
    m = x.mean(dim=axis, keepdim=True)
    v = x.var(dim=axis, keepdim=True, unbiased=False)
    return (x - m) / torch.sqrt(v + eps)
def _scatter_add(tgt, idx, src, axis=0):
    return tgt.clone().index_add_(axis, idx, src)
def _segment_sum(src, seg, n):
    out = torch.zeros((n,) + src.shape[1:], dtype=src.dtype)
    return out.index_add_(0, seg, src)
def _pad(x, pw):
    flat = tuple(v for pair in reversed(pw) for v in pair)
    return torch.nn.functional.pad(x, flat)

kernel_name = 'sequential_preLN__mha_block_cached__swiglu_ffn__decode'

def setup_inputs():

    _w = (lambda a: (lambda t: t.to(torch.bfloat16) if t.is_floating_point() else t)(torch.as_tensor(a)))
    def _A_setup():
        B, Sq, D = 2, 1, 512
        H, Sk, Dh = 32, 8192, 128
        return {
            "x": _w((lambda *s: torch.randn(*s, dtype=torch.bfloat16) * 0.05)(B, Sq, D)),
            "k_cache": _w((lambda *s: torch.randn(*s, dtype=torch.bfloat16) * 3.2)(B, H, Sk, Dh)),
            "v_cache": _w((lambda *s: torch.randn(*s, dtype=torch.bfloat16) * 0.4)(B, H, Sk, Dh)),
            "wq": _w((lambda *s: torch.randn(*s, dtype=torch.bfloat16) * 3.2)(D, H * Dh) * (D ** -0.5)),
            "wo": _w((lambda *s: torch.randn(*s, dtype=torch.bfloat16) * 0.4)(H * Dh, D) * ((H * Dh) ** -0.5)),
        }
    _A_in = _A_setup()

    def _B_setup():
        B, S, D, F = 2, 1, 512, 1792
        return {
            "x": _w((lambda *s: torch.randn(*s, dtype=torch.bfloat16) * 0.05)(B, S, D)),
            "w_gate": _w((lambda *s: torch.randn(*s, dtype=torch.bfloat16) * 0.05)(D, F)),
            "w_up": _w((lambda *s: torch.randn(*s, dtype=torch.bfloat16) * 0.05)(D, F)),
            "w_down": _w((lambda *s: torch.randn(*s, dtype=torch.bfloat16) * 0.05)(F, D)),
        }
    _B_in = _B_setup()

    return {
        "A_x": _A_in["x"],
        "A_k_cache": _A_in["k_cache"],
        "A_v_cache": _A_in["v_cache"],
        "A_wq": _A_in["wq"],
        "A_wo": _A_in["wo"],
        "B_x": _B_in["x"],
        "B_w_gate": _B_in["w_gate"],
        "B_w_up": _B_in["w_up"],
        "B_w_down": _B_in["w_down"],
    }

def reference(A_x, A_k_cache, A_v_cache, A_wq, A_wo, B_x, B_w_gate, B_w_up, B_w_down):
    def _A_ref(x, k_cache, v_cache, wq, wo):
        B, Sq, D = x.shape
        H, Dh = 32, 128
        q = (lambda x, *d: x.permute(*d))((x @ wq).reshape(B, Sq, H, Dh), 0, 2, 1, 3)
        scores = torch.einsum("bhqd,bhkd->bhqk", q, k_cache) * (Dh ** -0.5)
        p = _softmax(scores, axis=-1)
        o = torch.einsum("bhqk,bhkd->bhqd", p, v_cache)
        return (lambda x, *d: x.permute(*d))(o, 0, 2, 1, 3).reshape(B, Sq, H * Dh) @ wo

    def _B_ref(x, w_gate, w_up, w_down):
        g = _silu(x @ w_gate)
        u = x @ w_up
        return (g * u) @ w_down

    x = A_x
    h = x + _A_ref(_layernorm(x, axis=-1), A_k_cache, A_v_cache, A_wq, A_wo)
    h2 = h + _B_ref(_layernorm(h, axis=-1), B_w_gate, B_w_up, B_w_down)
    return h2
```

```asm
; @launch grid=(256,1,1) block=(512,1,1) lds=74752
.amdgcn_target "amdgcn-amd-amdhsa--gfx950"
.text
.globl sequential_preLN__mha_block_cached__swiglu_ffn__decode_kernel
.p2align 8
.type sequential_preLN__mha_block_cached__swiglu_ffn__decode_kernel,@function
sequential_preLN__mha_block_cached__swiglu_ffn__decode_kernel:
  s_cmp_ge_u32 s2, 256
  s_cbranch_scc1 end_sequen_1
  s_load_dwordx8 s[4:11], s[0:1], 0
  s_load_dwordx2 s[12:13], s[0:1], 32
  s_load_dwordx8 s[16:23], s[0:1], 48
  s_load_dwordx2 s[14:15], s[0:1], 88
  v_and_b32 v1, 63, v0
  v_lshrrev_b32 v3, 6, v0
  v_lshlrev_b32 v2, 4, v1
  v_readfirstlane_b32 s3, v3
  s_and_b32 s60, s2, 31
  s_bfe_u32 s61, s2, 0x10005
  s_lshr_b32 s62, s2, 6
  v_lshrrev_b32 v16, 4, v1
  v_and_b32 v19, 15, v1
  s_waitcnt lgkmcnt(0)
  s_load_dword s76, s[14:15], 0
  s_lshl_b32 s65, s61, 5
  s_or_b32 s65, s65, s60
  s_lshl_b32 s66, s65, 21
  s_lshr_b32 s67, s65, 11
  s_lshl_b32 s68, s62, 19
  s_add_u32 s66, s66, s68
  s_add_u32 s24, s6, s66
  s_addc_u32 s25, s7, s67
  s_and_b32 s25, s25, 0xffff
  s_mov_b32 s27, 0x20000
  s_mov_b32 s26, 524288
  s_add_u32 s28, s8, s66
  s_addc_u32 s29, s9, s67
  s_and_b32 s29, s29, 0xffff
  s_mov_b32 s31, 0x20000
  s_mov_b32 s30, 524288
  s_lshr_b32 s64, s3, 2
  s_lshl_b32 s64, s64, 18
  s_and_b32 s65, s3, 3
  s_lshl_b32 s65, s65, 12
  s_add_u32 s64, s64, s65
  s_cmp_lt_u32 s3, 4
  s_cbranch_scc1 ctl_sequen_2
  s_add_u32 s65, s64, 0
  buffer_load_dwordx4 v[64:67], v2, s[24:27], s65 offen offset:0 nt
  buffer_load_dwordx4 v[68:71], v2, s[24:27], s65 offen offset:1024 nt
  buffer_load_dwordx4 v[72:75], v2, s[24:27], s65 offen offset:2048 nt
  buffer_load_dwordx4 v[76:79], v2, s[24:27], s65 offen offset:3072 nt
  s_add_u32 s65, s64, 16384
  buffer_load_dwordx4 v[80:83], v2, s[24:27], s65 offen offset:0 nt
  buffer_load_dwordx4 v[84:87], v2, s[24:27], s65 offen offset:1024 nt
  buffer_load_dwordx4 v[88:91], v2, s[24:27], s65 offen offset:2048 nt
  buffer_load_dwordx4 v[92:95], v2, s[24:27], s65 offen offset:3072 nt
  s_add_u32 s65, s64, 32768
  buffer_load_dwordx4 v[96:99], v2, s[24:27], s65 offen offset:0 nt
  buffer_load_dwordx4 v[100:103], v2, s[24:27], s65 offen offset:1024 nt
  buffer_load_dwordx4 v[104:107], v2, s[24:27], s65 offen offset:2048 nt
  buffer_load_dwordx4 v[108:111], v2, s[24:27], s65 offen offset:3072 nt
  s_add_u32 s65, s64, 49152
  buffer_load_dwordx4 v[112:115], v2, s[24:27], s65 offen offset:0 nt
  buffer_load_dwordx4 v[116:119], v2, s[24:27], s65 offen offset:1024 nt
  buffer_load_dwordx4 v[120:123], v2, s[24:27], s65 offen offset:2048 nt
  buffer_load_dwordx4 v[124:127], v2, s[24:27], s65 offen offset:3072 nt
  s_barrier
  s_add_u32 s65, s64, 65536
  buffer_load_dwordx4 v[128:131], v2, s[24:27], s65 offen offset:0 nt
  buffer_load_dwordx4 v[132:135], v2, s[24:27], s65 offen offset:1024 nt
  buffer_load_dwordx4 v[136:139], v2, s[24:27], s65 offen offset:2048 nt
  buffer_load_dwordx4 v[140:143], v2, s[24:27], s65 offen offset:3072 nt
  s_add_u32 s65, s64, 81920
  buffer_load_dwordx4 v[144:147], v2, s[24:27], s65 offen offset:0 nt
  buffer_load_dwordx4 v[148:151], v2, s[24:27], s65 offen offset:1024 nt
  buffer_load_dwordx4 v[152:155], v2, s[24:27], s65 offen offset:2048 nt
  buffer_load_dwordx4 v[156:159], v2, s[24:27], s65 offen offset:3072 nt
  s_branch jq_sequen_3
ctl_sequen_2:
  s_lshl_b32 s65, s61, 10
  s_add_u32 s40, s4, s65
  s_addc_u32 s41, s5, 0
  s_and_b32 s41, s41, 0xffff
  s_mov_b32 s42, 1024
  s_mov_b32 s43, 0x20000
  s_mov_b32 s32, s10
  s_and_b32 s33, s11, 0xffff
  s_mov_b32 s34, 4194304
  s_mov_b32 s35, 0x20000
  buffer_load_dwordx4 v[4:7], v2, s[40:43], 0 offen
  v_lshlrev_b32 v17, 4, v16
  s_lshl_b32 s67, s62, 8
  s_lshl_b32 s68, s3, 6
  s_add_u32 s67, s67, s68
  buffer_load_dwordx4 v[32:35], v17, s[40:43], s67 offen
  v_lshlrev_b32 v18, 16, v16
  v_lshl_add_u32 v18, v19, 4, v18
  s_lshl_b32 s68, s62, 20
  s_lshl_b32 s69, s3, 18
  s_add_u32 s68, s68, s69
  s_lshl_b32 s69, s60, 8
  s_add_u32 s68, s68, s69
  buffer_load_dwordx4 v[128:131], v18, s[32:35], s68 offen
  s_add_u32 s68, s68, 8192
  buffer_load_dwordx4 v[132:135], v18, s[32:35], s68 offen
  s_add_u32 s68, s68, 8192
  buffer_load_dwordx4 v[136:139], v18, s[32:35], s68 offen
  s_add_u32 s68, s68, 8192
  buffer_load_dwordx4 v[140:143], v18, s[32:35], s68 offen
  s_add_u32 s68, s68, 8192
  buffer_load_dwordx4 v[144:147], v18, s[32:35], s68 offen
  s_add_u32 s68, s68, 8192
  buffer_load_dwordx4 v[148:151], v18, s[32:35], s68 offen
  s_add_u32 s68, s68, 8192
  buffer_load_dwordx4 v[152:155], v18, s[32:35], s68 offen
  s_add_u32 s68, s68, 8192
  buffer_load_dwordx4 v[156:159], v18, s[32:35], s68 offen
  s_mov_b32 s44, s14
  s_and_b32 s45, s15, 0xffff
  s_mov_b32 s46, 2097152
  s_mov_b32 s47, 0x20000
  v_and_b32 v20, 1, v1
  v_cmp_eq_u32 vcc, 1, v20
  v_mov_b32 v21, 0xffff
  v_mov_b32 v22, 0xffff0000
  v_cndmask_b32 v21, v21, v22, vcc
  v_bfe_u32 v20, v1, 1, 2
  v_cmp_eq_u32 vcc, 0, v20
  s_nop 1
  v_cndmask_b32 v196, 0, v21, vcc
  v_cmp_eq_u32 vcc, 1, v20
  s_nop 1
  v_cndmask_b32 v197, 0, v21, vcc
  v_cmp_eq_u32 vcc, 2, v20
  s_nop 1
  v_cndmask_b32 v198, 0, v21, vcc
  v_cmp_eq_u32 vcc, 3, v20
  s_nop 1
  v_cndmask_b32 v199, 0, v21, vcc
  v_lshlrev_b32 v36, 5, v19
  v_and_b32 v25, 1, v16
  v_lshl_add_u32 v36, v25, 4, v36
  s_lshl_b32 s65, s3, 9
  v_add_u32 v36, s65, v36
  s_mov_b32 s70, 0x01000100
  s_mov_b32 s71, 0x03020302
  s_waitcnt vmcnt(9)
  v_lshlrev_b32 v24, 16, v4
  v_and_b32 v25, 0xffff0000, v4
  v_lshlrev_b32 v26, 16, v5
  v_and_b32 v27, 0xffff0000, v5
  v_lshlrev_b32 v28, 16, v6
  v_and_b32 v29, 0xffff0000, v6
  v_lshlrev_b32 v30, 16, v7
  v_and_b32 v31, 0xffff0000, v7
  s_nop 0
  v_readfirstlane_b32 s65, v24
  s_nop 1
  v_subrev_f32 v8, s65, v24
  v_subrev_f32 v9, s65, v25
  v_subrev_f32 v10, s65, v26
  v_subrev_f32 v11, s65, v27
  v_subrev_f32 v12, s65, v28
  v_subrev_f32 v13, s65, v29
  v_subrev_f32 v14, s65, v30
  v_subrev_f32 v15, s65, v31
  v_add_f32 v20, v8, v9
  v_mul_f32 v21, v8, v8
  v_fmac_f32 v21, v9, v9
  v_add_f32 v20, v20, v10
  v_fmac_f32 v21, v10, v10
  v_add_f32 v20, v20, v11
  v_fmac_f32 v21, v11, v11
  v_add_f32 v20, v20, v12
  v_fmac_f32 v21, v12, v12
  v_add_f32 v20, v20, v13
  v_fmac_f32 v21, v13, v13
  v_add_f32 v20, v20, v14
  v_fmac_f32 v21, v14, v14
  v_add_f32 v20, v20, v15
  v_fmac_f32 v21, v15, v15
  s_nop 0
  v_add_f32_dpp v20, v20, v20 row_ror:8 row_mask:0xf bank_mask:0xf
  v_add_f32_dpp v21, v21, v21 row_ror:8 row_mask:0xf bank_mask:0xf
  s_nop 0
  v_add_f32_dpp v20, v20, v20 row_ror:4 row_mask:0xf bank_mask:0xf
  v_add_f32_dpp v21, v21, v21 row_ror:4 row_mask:0xf bank_mask:0xf
  s_nop 0
  v_add_f32_dpp v20, v20, v20 row_ror:2 row_mask:0xf bank_mask:0xf
  v_add_f32_dpp v21, v21, v21 row_ror:2 row_mask:0xf bank_mask:0xf
  s_nop 0
  v_add_f32_dpp v20, v20, v20 row_ror:1 row_mask:0xf bank_mask:0xf
  v_add_f32_dpp v21, v21, v21 row_ror:1 row_mask:0xf bank_mask:0xf
  s_nop 0
  v_mov_b32 v22, v20
  v_mov_b32 v24, v21
  s_nop 0
  v_permlane16_swap_b32 v20, v22
  v_permlane16_swap_b32 v21, v24
  v_add_f32 v20, v20, v22
  v_add_f32 v21, v21, v24
  v_mov_b32 v22, v20
  v_mov_b32 v24, v21
  s_nop 0
  v_permlane32_swap_b32 v20, v22
  v_permlane32_swap_b32 v21, v24
  v_add_f32 v20, v20, v22
  v_add_f32 v21, v21, v24
  v_mul_f32 v20, 0x3b000000, v20
  v_mul_f32 v21, 0x3b000000, v21
  v_fma_f32 v21, -v20, v20, v21
  v_add_f32 v20, s65, v20
  v_max_f32 v21, 0, v21
  v_cvt_pk_bf16_f32 v21, v21, v20
  v_and_b32 v20, 0xffff0000, v21
  v_lshlrev_b32 v21, 16, v21
  v_add_f32 v21, 0x3727c5ac, v21
  v_cvt_pk_bf16_f32 v21, v21, v21
  v_lshlrev_b32 v21, 16, v21
  v_sqrt_f32 v21, v21
  s_nop 0
  v_cvt_pk_bf16_f32 v21, v21, v21
  v_lshlrev_b32 v21, 16, v21
  v_rcp_f32 v23, v21
  s_nop 0
  s_waitcnt vmcnt(8)
  v_lshlrev_b32 v4, 16, v32
  v_and_b32 v5, 0xffff0000, v32
  v_lshlrev_b32 v6, 16, v33
  v_and_b32 v7, 0xffff0000, v33
  v_lshlrev_b32 v8, 16, v34
  v_and_b32 v9, 0xffff0000, v34
  v_lshlrev_b32 v10, 16, v35
  v_and_b32 v11, 0xffff0000, v35
  v_sub_f32 v4, v4, v20
  v_sub_f32 v5, v5, v20
  v_sub_f32 v6, v6, v20
  v_sub_f32 v7, v7, v20
  v_sub_f32 v8, v8, v20
  v_sub_f32 v9, v9, v20
  v_sub_f32 v10, v10, v20
  v_sub_f32 v11, v11, v20
  v_cvt_pk_bf16_f32 v4, v4, v5
  v_and_b32 v5, 0xffff0000, v4
  v_lshlrev_b32 v4, 16, v4
  v_cvt_pk_bf16_f32 v6, v6, v7
  v_and_b32 v7, 0xffff0000, v6
  v_lshlrev_b32 v6, 16, v6
  v_cvt_pk_bf16_f32 v8, v8, v9
  v_and_b32 v9, 0xffff0000, v8
  v_lshlrev_b32 v8, 16, v8
  v_cvt_pk_bf16_f32 v10, v10, v11
  v_and_b32 v11, 0xffff0000, v10
  v_lshlrev_b32 v10, 16, v10
  v_mul_f32 v4, v4, v23
  v_mul_f32 v5, v5, v23
  v_mul_f32 v6, v6, v23
  v_mul_f32 v7, v7, v23
  v_mul_f32 v8, v8, v23
  v_mul_f32 v9, v9, v23
  v_mul_f32 v10, v10, v23
  v_mul_f32 v11, v11, v23
  v_cvt_pk_bf16_f32 v48, v4, v5
  v_cvt_pk_bf16_f32 v49, v6, v7
  v_cvt_pk_bf16_f32 v50, v8, v9
  v_cvt_pk_bf16_f32 v51, v10, v11
  s_waitcnt vmcnt(4)
  v_perm_b32 v22, v48, v48, s70
  v_and_b32 v200, v22, v196
  v_and_b32 v201, v22, v197
  v_and_b32 v202, v22, v198
  v_and_b32 v203, v22, v199
  s_nop 1
  v_mfma_f32_16x16x32_bf16 v[216:219], v[200:203], v[128:131], 0
  v_perm_b32 v22, v48, v48, s71
  v_and_b32 v204, v22, v196
  v_and_b32 v205, v22, v197
  v_and_b32 v206, v22, v198
  v_and_b32 v207, v22, v199
  s_nop 1
  v_mfma_f32_16x16x32_bf16 v[220:223], v[204:207], v[132:135], 0
  v_perm_b32 v22, v49, v49, s70
  v_and_b32 v208, v22, v196
  v_and_b32 v209, v22, v197
  v_and_b32 v210, v22, v198
  v_and_b32 v211, v22, v199
  s_nop 1
  v_mfma_f32_16x16x32_bf16 v[216:219], v[208:211], v[136:139], v[216:219]
  v_perm_b32 v22, v49, v49, s71
  v_and_b32 v212, v22, v196
  v_and_b32 v213, v22, v197
  v_and_b32 v214, v22, v198
  v_and_b32 v215, v22, v199
  s_nop 1
  v_mfma_f32_16x16x32_bf16 v[220:223], v[212:215], v[140:143], v[220:223]
  s_waitcnt vmcnt(0)
  v_perm_b32 v22, v50, v50, s70
  v_and_b32 v200, v22, v196
  v_and_b32 v201, v22, v197
  v_and_b32 v202, v22, v198
  v_and_b32 v203, v22, v199
  s_nop 1
  v_mfma_f32_16x16x32_bf16 v[216:219], v[200:203], v[144:147], v[216:219]
  v_perm_b32 v22, v50, v50, s71
  v_and_b32 v204, v22, v196
  v_and_b32 v205, v22, v197
  v_and_b32 v206, v22, v198
  v_and_b32 v207, v22, v199
  s_nop 1
  v_mfma_f32_16x16x32_bf16 v[220:223], v[204:207], v[148:151], v[220:223]
  v_perm_b32 v22, v51, v51, s70
  v_and_b32 v208, v22, v196
  v_and_b32 v209, v22, v197
  v_and_b32 v210, v22, v198
  v_and_b32 v211, v22, v199
  s_nop 1
  v_mfma_f32_16x16x32_bf16 v[216:219], v[208:211], v[152:155], v[216:219]
  v_perm_b32 v22, v51, v51, s71
  v_and_b32 v212, v22, v196
  v_and_b32 v213, v22, v197
  v_and_b32 v214, v22, v198
  v_and_b32 v215, v22, v199
  s_nop 1
  v_mfma_f32_16x16x32_bf16 v[220:223], v[212:215], v[156:159], v[220:223]
  v_cmp_gt_u32 vcc, 32, v1
  s_nop 6
  v_add_f32 v216, v216, v220
  v_add_f32 v217, v217, v221
  v_add_f32 v218, v218, v222
  v_add_f32 v219, v219, v223
  s_and_saveexec_b64 s[82:83], vcc
  ds_write_b128 v36, v[216:219]
  s_mov_b64 exec, s[82:83]
  s_waitcnt lgkmcnt(0)
  s_barrier
  s_cmp_lg_u32 s3, 0
  s_cbranch_scc1 np0_sequen_4
  v_lshlrev_b32 v36, 5, v19
  v_and_b32 v25, 1, v16
  v_lshl_add_u32 v36, v25, 4, v36
  ds_read_b128 v[12:15], v36 offset:0
  ds_read_b128 v[16:19], v36 offset:512
  ds_read_b128 v[20:23], v36 offset:1024
  ds_read_b128 v[24:27], v36 offset:1536
  s_add_u32 s79, s76, 1
  v_lshlrev_b32 v28, 5, v1
  s_lshl_b32 s65, s2, 10
  s_add_u32 s65, s65, 1048576
  v_mov_b32 v5, s79
  v_mov_b32 v7, s79
  v_mov_b32 v9, s79
  v_mov_b32 v11, s79
  s_waitcnt lgkmcnt(0)
  v_add_f32 v12, v12, v16
  v_add_f32 v20, v20, v24
  v_add_f32 v13, v13, v17
  v_add_f32 v21, v21, v25
  v_add_f32 v14, v14, v18
  v_add_f32 v22, v22, v26
  v_add_f32 v15, v15, v19
  v_add_f32 v23, v23, v27
  v_add_f32 v4, v12, v20
  v_add_f32 v6, v13, v21
  v_add_f32 v8, v14, v22
  v_add_f32 v10, v15, v23
  v_cmp_gt_u32 vcc, 32, v1
  s_and_saveexec_b64 s[82:83], vcc
  buffer_store_dwordx4 v[4:7], v28, s[44:47], s65 offen sc1
  buffer_store_dwordx4 v[8:11], v28, s[44:47], s65 offen offset:16 sc1
  s_mov_b64 exec, s[82:83]
np0_sequen_4:
  s_add_u32 s65, s64, 0
  buffer_load_dwordx4 v[64:67], v2, s[24:27], s65 offen offset:0 nt
  buffer_load_dwordx4 v[68:71], v2, s[24:27], s65 offen offset:1024 nt
  buffer_load_dwordx4 v[72:75], v2, s[24:27], s65 offen offset:2048 nt
  buffer_load_dwordx4 v[76:79], v2, s[24:27], s65 offen offset:3072 nt
  s_add_u32 s65, s64, 16384
  buffer_load_dwordx4 v[80:83], v2, s[24:27], s65 offen offset:0 nt
  buffer_load_dwordx4 v[84:87], v2, s[24:27], s65 offen offset:1024 nt
  buffer_load_dwordx4 v[88:91], v2, s[24:27], s65 offen offset:2048 nt
  buffer_load_dwordx4 v[92:95], v2, s[24:27], s65 offen offset:3072 nt
  s_add_u32 s65, s64, 32768
  buffer_load_dwordx4 v[96:99], v2, s[24:27], s65 offen offset:0 nt
  buffer_load_dwordx4 v[100:103], v2, s[24:27], s65 offen offset:1024 nt
  buffer_load_dwordx4 v[104:107], v2, s[24:27], s65 offen offset:2048 nt
  buffer_load_dwordx4 v[108:111], v2, s[24:27], s65 offen offset:3072 nt
  s_add_u32 s65, s64, 49152
  buffer_load_dwordx4 v[112:115], v2, s[24:27], s65 offen offset:0 nt
  buffer_load_dwordx4 v[116:119], v2, s[24:27], s65 offen offset:1024 nt
  buffer_load_dwordx4 v[120:123], v2, s[24:27], s65 offen offset:2048 nt
  buffer_load_dwordx4 v[124:127], v2, s[24:27], s65 offen offset:3072 nt
  s_add_u32 s65, s64, 65536
  buffer_load_dwordx4 v[128:131], v2, s[24:27], s65 offen offset:0 nt
  buffer_load_dwordx4 v[132:135], v2, s[24:27], s65 offen offset:1024 nt
  buffer_load_dwordx4 v[136:139], v2, s[24:27], s65 offen offset:2048 nt
  buffer_load_dwordx4 v[140:143], v2, s[24:27], s65 offen offset:3072 nt
  s_add_u32 s65, s64, 81920
  buffer_load_dwordx4 v[144:147], v2, s[24:27], s65 offen offset:0 nt
  buffer_load_dwordx4 v[148:151], v2, s[24:27], s65 offen offset:1024 nt
  buffer_load_dwordx4 v[152:155], v2, s[24:27], s65 offen offset:2048 nt
  buffer_load_dwordx4 v[156:159], v2, s[24:27], s65 offen offset:3072 nt
  s_cmp_lg_u32 s3, 0
  s_cbranch_scc1 jq_sequen_3
  s_and_b32 s66, s2, 63
  s_lshl_b32 s66, s66, 10
  s_add_u32 s66, s66, 1048576
  s_mov_b32 s84, 20000
qp_sequen_5:
  buffer_load_dwordx4 v[32:35], v2, s[44:47], s66 offen sc1
  s_add_u32 s66, s66, 65536
  buffer_load_dwordx4 v[36:39], v2, s[44:47], s66 offen sc1
  s_add_u32 s66, s66, 65536
  buffer_load_dwordx4 v[40:43], v2, s[44:47], s66 offen sc1
  s_add_u32 s66, s66, 65536
  buffer_load_dwordx4 v[44:47], v2, s[44:47], s66 offen sc1
  s_sub_u32 s66, s66, 196608
  s_waitcnt vmcnt(0)
  v_xor_b32 v4, s79, v33
  v_xor_b32 v5, s79, v35
  v_xor_b32 v6, s79, v37
  v_xor_b32 v7, s79, v39
  v_or3_b32 v4, v4, v6, v7
  v_xor_b32 v6, s79, v41
  v_xor_b32 v7, s79, v43
  v_or3_b32 v4, v4, v6, v7
  v_xor_b32 v6, s79, v45
  v_xor_b32 v7, s79, v47
  v_or3_b32 v4, v4, v6, v7
  v_or_b32 v4, v4, v5
  v_cmp_ne_u32 vcc, 0, v4
  s_cbranch_vccz qd_sequen_6
  s_sub_u32 s84, s84, 1
  s_cbranch_scc0 qp_sequen_5
qd_sequen_6:
  v_add_f32 v4, v32, v36
  v_add_f32 v5, v34, v38
  v_add_f32 v6, v40, v44
  v_add_f32 v7, v42, v46
  v_add_f32 v4, v4, v6
  v_add_f32 v5, v5, v7
  v_cvt_pk_bf16_f32 v4, v4, v5
  v_bfe_u32 v5, v1, 1, 4
  v_lshlrev_b32 v5, 2, v5
  v_lshrrev_b32 v6, 5, v1
  v_lshl_add_u32 v5, v6, 1, v5
  v_and_b32 v6, 1, v1
  v_add_u32 v5, v5, v6
  v_lshlrev_b32 v5, 2, v5
  ds_write_b32 v5, v4 offset:4096
  s_waitcnt lgkmcnt(0)
jq_sequen_3:
  s_barrier
  v_lshrrev_b32 v16, 4, v1
  v_and_b32 v19, 15, v1
  v_lshlrev_b32 v24, 4, v19
  ds_read_b128 v[192:195], v24 offset:4096
  s_add_u32 s65, s64, 98304
  buffer_load_dwordx4 v[160:163], v2, s[24:27], s65 offen offset:0 nt
  buffer_load_dwordx4 v[164:167], v2, s[24:27], s65 offen offset:1024 nt
  buffer_load_dwordx4 v[168:171], v2, s[24:27], s65 offen offset:2048 nt
  buffer_load_dwordx4 v[172:175], v2, s[24:27], s65 offen offset:3072 nt
  s_add_u32 s65, s64, 114688
  buffer_load_dwordx4 v[176:179], v2, s[24:27], s65 offen offset:0 nt
  buffer_load_dwordx4 v[180:183], v2, s[24:27], s65 offen offset:1024 nt
  buffer_load_dwordx4 v[184:187], v2, s[24:27], s65 offen offset:2048 nt
  buffer_load_dwordx4 v[188:191], v2, s[24:27], s65 offen offset:3072 nt
  s_mov_b32 s36, s12
  s_and_b32 s37, s13, 0xffff
  s_mov_b32 s38, 4194304
  s_mov_b32 s39, 0x20000
  s_mov_b32 s44, s14
  s_and_b32 s45, s15, 0xffff
  s_mov_b32 s46, 2097152
  s_mov_b32 s47, 0x20000
  s_and_b32 s65, s2, 1
  s_lshr_b32 s87, s2, 1
  s_mov_b32 s85, 0
  s_cmp_lt_u32 s2, 224
  s_cselect_b32 s66, 1, 0
  s_cmp_eq_u32 s65, 0
  s_cselect_b32 s85, s66, 0
  s_cmp_ge_u32 s2, 192
  s_cselect_b32 s66, 2, 0
  s_cmp_eq_u32 s65, 1
  s_cselect_b32 s85, s66, s85
  s_sub_u32 s66, s87, 96
  s_cmp_eq_u32 s85, 2
  s_cselect_b32 s87, s66, s87
  s_cmp_eq_u32 s85, 1
  s_cselect_b32 s50, 1835008, 0
  s_cselect_b32 s58, 1835008, 0
  s_mov_b32 s48, s16
  s_and_b32 s49, s17, 0xffff
  s_mov_b32 s51, 0x20000
  s_mov_b32 s52, s18
  s_and_b32 s53, s19, 0xffff
  s_mov_b32 s54, s50
  s_mov_b32 s55, 0x20000
  s_mov_b32 s56, s20
  s_and_b32 s57, s21, 0xffff
  s_mov_b32 s59, 0x20000
  s_bfe_u32 s65, s2, 0x20001
  s_mul_i32 s65, s65, 28
  s_lshr_b32 s66, s2, 3
  s_add_u32 s73, s65, s66
  v_lshrrev_b32 v20, 1, v1
  v_and_b32 v21, 1, v1
  s_mov_b32 s65, 3584
  v_mul_lo_u32 v228, v20, s65
  v_lshl_add_u32 v228, v21, 4, v228
  s_mul_i32 s74, s3, 229376
  s_lshl_b32 s65, s73, 5
  s_add_u32 s74, s74, s65
  s_lshl_b32 s75, s73, 14
  s_lshl_b32 s65, s3, 11
  s_add_u32 s75, s75, s65
  v_and_b32 v20, 1, v1
  v_cmp_eq_u32 vcc, 1, v20
  v_mov_b32 v21, 0xffff
  v_mov_b32 v22, 0xffff0000
  v_cndmask_b32 v21, v21, v22, vcc
  v_bfe_u32 v20, v1, 1, 2
  v_cmp_eq_u32 vcc, 0, v20
  s_nop 1
  v_cndmask_b32 v196, 0, v21, vcc
  v_cmp_eq_u32 vcc, 1, v20
  s_nop 1
  v_cndmask_b32 v197, 0, v21, vcc
  v_cmp_eq_u32 vcc, 2, v20
  s_nop 1
  v_cndmask_b32 v198, 0, v21, vcc
  v_cmp_eq_u32 vcc, 3, v20
  s_nop 1
  v_cndmask_b32 v199, 0, v21, vcc
  s_mov_b32 s70, 0x01000100
  s_mov_b32 s71, 0x03020302
  v_lshlrev_b32 v224, 5, v19
  v_and_b32 v25, 1, v16
  v_lshl_add_u32 v224, v25, 4, v224
  s_lshl_b32 s65, s3, 9
  v_add_u32 v224, s65, v224
  s_waitcnt lgkmcnt(0)
  s_add_u32 s79, s76, 1
  s_and_b32 s77, s79, 0x3ff
  s_and_b32 s78, s79, 0xffff
  s_mov_b32 s80, 0x3db504f3
  s_mov_b32 s81, 0x3fb8aa3b
  v_lshrrev_b32 v225, 4, v1
  v_and_b32 v226, 15, v1
  v_lshlrev_b32 v227, 12, v225
  v_lshl_add_u32 v227, v226, 4, v227
  s_lshl_b32 s72, s60, 17
  s_lshl_b32 s65, s3, 14
  s_add_u32 s72, s72, s65
  v_mov_b32 v4, 0xff800000
  s_waitcnt vmcnt(28)
  v_dot2_f32_bf16 v8, v64, v192, 0
  v_dot2_f32_bf16 v9, v68, v192, 0
  v_dot2_f32_bf16 v10, v72, v192, 0
  v_dot2_f32_bf16 v11, v76, v192, 0
  v_dot2_f32_bf16 v8, v65, v193, v8
  v_dot2_f32_bf16 v9, v69, v193, v9
  v_dot2_f32_bf16 v10, v73, v193, v10
  v_dot2_f32_bf16 v11, v77, v193, v11
  v_dot2_f32_bf16 v8, v66, v194, v8
  v_dot2_f32_bf16 v9, v70, v194, v9
  v_dot2_f32_bf16 v10, v74, v194, v10
  v_dot2_f32_bf16 v11, v78, v194, v11
  v_dot2_f32_bf16 v8, v67, v195, v8
  v_dot2_f32_bf16 v9, v71, v195, v9
  v_dot2_f32_bf16 v10, v75, v195, v10
  v_dot2_f32_bf16 v11, v79, v195, v11
  s_add_u32 s65, s64, 131072
  buffer_load_dwordx4 v[64:67], v2, s[24:27], s65 offen offset:0 nt
  buffer_load_dwordx4 v[68:71], v2, s[24:27], s65 offen offset:1024 nt
  buffer_load_dwordx4 v[72:75], v2, s[24:27], s65 offen offset:2048 nt
  buffer_load_dwordx4 v[76:79], v2, s[24:27], s65 offen offset:3072 nt
  v_add_f32_dpp v8, v8, v8 row_ror:8 row_mask:0xf bank_mask:0xf
  v_add_f32_dpp v9, v9, v9 row_ror:8 row_mask:0xf bank_mask:0xf
  v_add_f32_dpp v10, v10, v10 row_ror:8 row_mask:0xf bank_mask:0xf
  v_add_f32_dpp v11, v11, v11 row_ror:8 row_mask:0xf bank_mask:0xf
  v_add_f32_dpp v8, v8, v8 row_ror:4 row_mask:0xf bank_mask:0xf
  v_add_f32_dpp v9, v9, v9 row_ror:4 row_mask:0xf bank_mask:0xf
  v_add_f32_dpp v10, v10, v10 row_ror:4 row_mask:0xf bank_mask:0xf
  v_add_f32_dpp v11, v11, v11 row_ror:4 row_mask:0xf bank_mask:0xf
  v_add_f32_dpp v8, v8, v8 row_ror:2 row_mask:0xf bank_mask:0xf
  v_add_f32_dpp v9, v9, v9 row_ror:2 row_mask:0xf bank_mask:0xf
  v_add_f32_dpp v10, v10, v10 row_ror:2 row_mask:0xf bank_mask:0xf
  v_add_f32_dpp v11, v11, v11 row_ror:2 row_mask:0xf bank_mask:0xf
  v_add_f32_dpp v8, v8, v8 row_ror:1 row_mask:0xf bank_mask:0xf
  v_add_f32_dpp v9, v9, v9 row_ror:1 row_mask:0xf bank_mask:0xf
  v_add_f32_dpp v10, v10, v10 row_ror:1 row_mask:0xf bank_mask:0xf
  v_add_f32_dpp v11, v11, v11 row_ror:1 row_mask:0xf bank_mask:0xf
  v_cvt_pk_bf16_f32 v12, v8, v9
  v_cvt_pk_bf16_f32 v13, v10, v11
  v_lshlrev_b32 v8, 16, v12
  v_and_b32 v9, 0xffff0000, v12
  v_lshlrev_b32 v10, 16, v13
  v_and_b32 v11, 0xffff0000, v13
  v_mul_f32 v8, s80, v8
  v_mul_f32 v9, s80, v9
  v_mul_f32 v10, s80, v10
  v_mul_f32 v11, s80, v11
  v_cvt_pk_bf16_f32 v32, v8, v9
  v_cvt_pk_bf16_f32 v33, v10, v11
  v_max3_f32 v4, v4, v8, v9
  v_max3_f32 v4, v4, v10, v11
  s_waitcnt vmcnt(28)
  v_dot2_f32_bf16 v8, v80, v192, 0
  v_dot2_f32_bf16 v9, v84, v192, 0
  v_dot2_f32_bf16 v10, v88, v192, 0
  v_dot2_f32_bf16 v11, v92, v192, 0
  v_dot2_f32_bf16 v8, v81, v193, v8
  v_dot2_f32_bf16 v9, v85, v193, v9
  v_dot2_f32_bf16 v10, v89, v193, v10
  v_dot2_f32_bf16 v11, v93, v193, v11
  v_dot2_f32_bf16 v8, v82, v194, v8
  v_dot2_f32_bf16 v9, v86, v194, v9
  v_dot2_f32_bf16 v10, v90, v194, v10
  v_dot2_f32_bf16 v11, v94, v194, v11
  v_dot2_f32_bf16 v8, v83, v195, v8
  v_dot2_f32_bf16 v9, v87, v195, v9
  v_dot2_f32_bf16 v10, v91, v195, v10
  v_dot2_f32_bf16 v11, v95, v195, v11
  s_add_u32 s65, s64, 147456
  buffer_load_dwordx4 v[80:83], v2, s[24:27], s65 offen offset:0 nt
  buffer_load_dwordx4 v[84:87], v2, s[24:27], s65 offen offset:1024 nt
  buffer_load_dwordx4 v[88:91], v2, s[24:27], s65 offen offset:2048 nt
  buffer_load_dwordx4 v[92:95], v2, s[24:27], s65 offen offset:3072 nt
  v_add_f32_dpp v8, v8, v8 row_ror:8 row_mask:0xf bank_mask:0xf
  v_add_f32_dpp v9, v9, v9 row_ror:8 row_mask:0xf bank_mask:0xf
  v_add_f32_dpp v10, v10, v10 row_ror:8 row_mask:0xf bank_mask:0xf
  v_add_f32_dpp v11, v11, v11 row_ror:8 row_mask:0xf bank_mask:0xf
  v_add_f32_dpp v8, v8, v8 row_ror:4 row_mask:0xf bank_mask:0xf
  v_add_f32_dpp v9, v9, v9 row_ror:4 row_mask:0xf bank_mask:0xf
  v_add_f32_dpp v10, v10, v10 row_ror:4 row_mask:0xf bank_mask:0xf
  v_add_f32_dpp v11, v11, v11 row_ror:4 row_mask:0xf bank_mask:0xf
  v_add_f32_dpp v8, v8, v8 row_ror:2 row_mask:0xf bank_mask:0xf
  v_add_f32_dpp v9, v9, v9 row_ror:2 row_mask:0xf bank_mask:0xf
  v_add_f32_dpp v10, v10, v10 row_ror:2 row_mask:0xf bank_mask:0xf
  v_add_f32_dpp v11, v11, v11 row_ror:2 row_mask:0xf bank_mask:0xf
  v_add_f32_dpp v8, v8, v8 row_ror:1 row_mask:0xf bank_mask:0xf
  v_add_f32_dpp v9, v9, v9 row_ror:1 row_mask:0xf bank_mask:0xf
  v_add_f32_dpp v10, v10, v10 row_ror:1 row_mask:0xf bank_mask:0xf
  v_add_f32_dpp v11, v11, v11 row_ror:1 row_mask:0xf bank_mask:0xf
  v_cvt_pk_bf16_f32 v12, v8, v9
  v_cvt_pk_bf16_f32 v13, v10, v11
  v_lshlrev_b32 v8, 16, v12
  v_and_b32 v9, 0xffff0000, v12
  v_lshlrev_b32 v10, 16, v13
  v_and_b32 v11, 0xffff0000, v13
  v_mul_f32 v8, s80, v8
  v_mul_f32 v9, s80, v9
  v_mul_f32 v10, s80, v10
  v_mul_f32 v11, s80, v11
  v_cvt_pk_bf16_f32 v34, v8, v9
  v_cvt_pk_bf16_f32 v35, v10, v11
  v_max3_f32 v4, v4, v8, v9
  v_max3_f32 v4, v4, v10, v11
  s_waitcnt vmcnt(28)
  v_dot2_f32_bf16 v8, v96, v192, 0
  v_dot2_f32_bf16 v9, v100, v192, 0
  v_dot2_f32_bf16 v10, v104, v192, 0
  v_dot2_f32_bf16 v11, v108, v192, 0
  v_dot2_f32_bf16 v8, v97, v193, v8
  v_dot2_f32_bf16 v9, v101, v193, v9
  v_dot2_f32_bf16 v10, v105, v193, v10
  v_dot2_f32_bf16 v11, v109, v193, v11
  v_dot2_f32_bf16 v8, v98, v194, v8
  v_dot2_f32_bf16 v9, v102, v194, v9
  v_dot2_f32_bf16 v10, v106, v194, v10
  v_dot2_f32_bf16 v11, v110, v194, v11
  v_dot2_f32_bf16 v8, v99, v195, v8
  v_dot2_f32_bf16 v9, v103, v195, v9
  v_dot2_f32_bf16 v10, v107, v195, v10
  v_dot2_f32_bf16 v11, v111, v195, v11
  s_add_u32 s65, s64, 163840
  buffer_load_dwordx4 v[96:99], v2, s[24:27], s65 offen offset:0 nt
  buffer_load_dwordx4 v[100:103], v2, s[24:27], s65 offen offset:1024 nt
  buffer_load_dwordx4 v[104:107], v2, s[24:27], s65 offen offset:2048 nt
  buffer_load_dwordx4 v[108:111], v2, s[24:27], s65 offen offset:3072 nt
  v_add_f32_dpp v8, v8, v8 row_ror:8 row_mask:0xf bank_mask:0xf
  v_add_f32_dpp v9, v9, v9 row_ror:8 row_mask:0xf bank_mask:0xf
  v_add_f32_dpp v10, v10, v10 row_ror:8 row_mask:0xf bank_mask:0xf
  v_add_f32_dpp v11, v11, v11 row_ror:8 row_mask:0xf bank_mask:0xf
  v_add_f32_dpp v8, v8, v8 row_ror:4 row_mask:0xf bank_mask:0xf
  v_add_f32_dpp v9, v9, v9 row_ror:4 row_mask:0xf bank_mask:0xf
  v_add_f32_dpp v10, v10, v10 row_ror:4 row_mask:0xf bank_mask:0xf
  v_add_f32_dpp v11, v11, v11 row_ror:4 row_mask:0xf bank_mask:0xf
  v_add_f32_dpp v8, v8, v8 row_ror:2 row_mask:0xf bank_mask:0xf
  v_add_f32_dpp v9, v9, v9 row_ror:2 row_mask:0xf bank_mask:0xf
  v_add_f32_dpp v10, v10, v10 row_ror:2 row_mask:0xf bank_mask:0xf
  v_add_f32_dpp v11, v11, v11 row_ror:2 row_mask:0xf bank_mask:0xf
  v_add_f32_dpp v8, v8, v8 row_ror:1 row_mask:0xf bank_mask:0xf
  v_add_f32_dpp v9, v9, v9 row_ror:1 row_mask:0xf bank_mask:0xf
  v_add_f32_dpp v10, v10, v10 row_ror:1 row_mask:0xf bank_mask:0xf
  v_add_f32_dpp v11, v11, v11 row_ror:1 row_mask:0xf bank_mask:0xf
  v_cvt_pk_bf16_f32 v12, v8, v9
  v_cvt_pk_bf16_f32 v13, v10, v11
  v_lshlrev_b32 v8, 16, v12
  v_and_b32 v9, 0xffff0000, v12
  v_lshlrev_b32 v10, 16, v13
  v_and_b32 v11, 0xffff0000, v13
  v_mul_f32 v8, s80, v8
  v_mul_f32 v9, s80, v9
  v_mul_f32 v10, s80, v10
  v_mul_f32 v11, s80, v11
  v_cvt_pk_bf16_f32 v36, v8, v9
  v_cvt_pk_bf16_f32 v37, v10, v11
  v_max3_f32 v4, v4, v8, v9
  v_max3_f32 v4, v4, v10, v11
  s_waitcnt vmcnt(28)
  v_dot2_f32_bf16 v8, v112, v192, 0
  v_dot2_f32_bf16 v9, v116, v192, 0
  v_dot2_f32_bf16 v10, v120, v192, 0
  v_dot2_f32_bf16 v11, v124, v192, 0
  v_dot2_f32_bf16 v8, v113, v193, v8
  v_dot2_f32_bf16 v9, v117, v193, v9
  v_dot2_f32_bf16 v10, v121, v193, v10
  v_dot2_f32_bf16 v11, v125, v193, v11
  v_dot2_f32_bf16 v8, v114, v194, v8
  v_dot2_f32_bf16 v9, v118, v194, v9
  v_dot2_f32_bf16 v10, v122, v194, v10
  v_dot2_f32_bf16 v11, v126, v194, v11
  v_dot2_f32_bf16 v8, v115, v195, v8
  v_dot2_f32_bf16 v9, v119, v195, v9
  v_dot2_f32_bf16 v10, v123, v195, v10
  v_dot2_f32_bf16 v11, v127, v195, v11
  s_add_u32 s65, s64, 180224
  buffer_load_dwordx4 v[112:115], v2, s[24:27], s65 offen offset:0 nt
  buffer_load_dwordx4 v[116:119], v2, s[24:27], s65 offen offset:1024 nt
  buffer_load_dwordx4 v[120:123], v2, s[24:27], s65 offen offset:2048 nt
  buffer_load_dwordx4 v[124:127], v2, s[24:27], s65 offen offset:3072 nt
  v_add_f32_dpp v8, v8, v8 row_ror:8 row_mask:0xf bank_mask:0xf
  v_add_f32_dpp v9, v9, v9 row_ror:8 row_mask:0xf bank_mask:0xf
  v_add_f32_dpp v10, v10, v10 row_ror:8 row_mask:0xf bank_mask:0xf
  v_add_f32_dpp v11, v11, v11 row_ror:8 row_mask:0xf bank_mask:0xf
  v_add_f32_dpp v8, v8, v8 row_ror:4 row_mask:0xf bank_mask:0xf
  v_add_f32_dpp v9, v9, v9 row_ror:4 row_mask:0xf bank_mask:0xf
  v_add_f32_dpp v10, v10, v10 row_ror:4 row_mask:0xf bank_mask:0xf
  v_add_f32_dpp v11, v11, v11 row_ror:4 row_mask:0xf bank_mask:0xf
  v_add_f32_dpp v8, v8, v8 row_ror:2 row_mask:0xf bank_mask:0xf
  v_add_f32_dpp v9, v9, v9 row_ror:2 row_mask:0xf bank_mask:0xf
  v_add_f32_dpp v10, v10, v10 row_ror:2 row_mask:0xf bank_mask:0xf
  v_add_f32_dpp v11, v11, v11 row_ror:2 row_mask:0xf bank_mask:0xf
  v_add_f32_dpp v8, v8, v8 row_ror:1 row_mask:0xf bank_mask:0xf
  v_add_f32_dpp v9, v9, v9 row_ror:1 row_mask:0xf bank_mask:0xf
  v_add_f32_dpp v10, v10, v10 row_ror:1 row_mask:0xf bank_mask:0xf
  v_add_f32_dpp v11, v11, v11 row_ror:1 row_mask:0xf bank_mask:0xf
  v_cvt_pk_bf16_f32 v12, v8, v9
  v_cvt_pk_bf16_f32 v13, v10, v11
  v_lshlrev_b32 v8, 16, v12
  v_and_b32 v9, 0xffff0000, v12
  v_lshlrev_b32 v10, 16, v13
  v_and_b32 v11, 0xffff0000, v13
  v_mul_f32 v8, s80, v8
  v_mul_f32 v9, s80, v9
  v_mul_f32 v10, s80, v10
  v_mul_f32 v11, s80, v11
  v_cvt_pk_bf16_f32 v38, v8, v9
  v_cvt_pk_bf16_f32 v39, v10, v11
  v_max3_f32 v4, v4, v8, v9
  v_max3_f32 v4, v4, v10, v11
  s_waitcnt vmcnt(28)
  v_dot2_f32_bf16 v8, v128, v192, 0
  v_dot2_f32_bf16 v9, v132, v192, 0
  v_dot2_f32_bf16 v10, v136, v192, 0
  v_dot2_f32_bf16 v11, v140, v192, 0
  v_dot2_f32_bf16 v8, v129, v193, v8
  v_dot2_f32_bf16 v9, v133, v193, v9
  v_dot2_f32_bf16 v10, v137, v193, v10
  v_dot2_f32_bf16 v11, v141, v193, v11
  v_dot2_f32_bf16 v8, v130, v194, v8
  v_dot2_f32_bf16 v9, v134, v194, v9
  v_dot2_f32_bf16 v10, v138, v194, v10
  v_dot2_f32_bf16 v11, v142, v194, v11
  v_dot2_f32_bf16 v8, v131, v195, v8
  v_dot2_f32_bf16 v9, v135, v195, v9
  v_dot2_f32_bf16 v10, v139, v195, v10
  v_dot2_f32_bf16 v11, v143, v195, v11
  s_nop 2
  v_add_f32_dpp v8, v8, v8 row_ror:8 row_mask:0xf bank_mask:0xf
  v_add_f32_dpp v9, v9, v9 row_ror:8 row_mask:0xf bank_mask:0xf
  v_add_f32_dpp v10, v10, v10 row_ror:8 row_mask:0xf bank_mask:0xf
  v_add_f32_dpp v11, v11, v11 row_ror:8 row_mask:0xf bank_mask:0xf
  v_add_f32_dpp v8, v8, v8 row_ror:4 row_mask:0xf bank_mask:0xf
  v_add_f32_dpp v9, v9, v9 row_ror:4 row_mask:0xf bank_mask:0xf
  v_add_f32_dpp v10, v10, v10 row_ror:4 row_mask:0xf bank_mask:0xf
  v_add_f32_dpp v11, v11, v11 row_ror:4 row_mask:0xf bank_mask:0xf
  v_add_f32_dpp v8, v8, v8 row_ror:2 row_mask:0xf bank_mask:0xf
  v_add_f32_dpp v9, v9, v9 row_ror:2 row_mask:0xf bank_mask:0xf
  v_add_f32_dpp v10, v10, v10 row_ror:2 row_mask:0xf bank_mask:0xf
  v_add_f32_dpp v11, v11, v11 row_ror:2 row_mask:0xf bank_mask:0xf
  v_add_f32_dpp v8, v8, v8 row_ror:1 row_mask:0xf bank_mask:0xf
  v_add_f32_dpp v9, v9, v9 row_ror:1 row_mask:0xf bank_mask:0xf
  v_add_f32_dpp v10, v10, v10 row_ror:1 row_mask:0xf bank_mask:0xf
  v_add_f32_dpp v11, v11, v11 row_ror:1 row_mask:0xf bank_mask:0xf
  v_cvt_pk_bf16_f32 v12, v8, v9
  v_cvt_pk_bf16_f32 v13, v10, v11
  v_lshlrev_b32 v8, 16, v12
  v_and_b32 v9, 0xffff0000, v12
  v_lshlrev_b32 v10, 16, v13
  v_and_b32 v11, 0xffff0000, v13
  v_mul_f32 v8, s80, v8
  v_mul_f32 v9, s80, v9
  v_mul_f32 v10, s80, v10
  v_mul_f32 v11, s80, v11
  v_cvt_pk_bf16_f32 v40, v8, v9
  v_cvt_pk_bf16_f32 v41, v10, v11
  v_max3_f32 v4, v4, v8, v9
  v_max3_f32 v4, v4, v10, v11
  s_waitcnt vmcnt(24)
  v_dot2_f32_bf16 v8, v144, v192, 0
  v_dot2_f32_bf16 v9, v148, v192, 0
  v_dot2_f32_bf16 v10, v152, v192, 0
  v_dot2_f32_bf16 v11, v156, v192, 0
  v_dot2_f32_bf16 v8, v145, v193, v8
  v_dot2_f32_bf16 v9, v149, v193, v9
  v_dot2_f32_bf16 v10, v153, v193, v10
  v_dot2_f32_bf16 v11, v157, v193, v11
  v_dot2_f32_bf16 v8, v146, v194, v8
  v_dot2_f32_bf16 v9, v150, v194, v9
  v_dot2_f32_bf16 v10, v154, v194, v10
  v_dot2_f32_bf16 v11, v158, v194, v11
  v_dot2_f32_bf16 v8, v147, v195, v8
  v_dot2_f32_bf16 v9, v151, v195, v9
  v_dot2_f32_bf16 v10, v155, v195, v10
  v_dot2_f32_bf16 v11, v159, v195, v11
  s_nop 2
  v_add_f32_dpp v8, v8, v8 row_ror:8 row_mask:0xf bank_mask:0xf
  v_add_f32_dpp v9, v9, v9 row_ror:8 row_mask:0xf bank_mask:0xf
  v_add_f32_dpp v10, v10, v10 row_ror:8 row_mask:0xf bank_mask:0xf
  v_add_f32_dpp v11, v11, v11 row_ror:8 row_mask:0xf bank_mask:0xf
  v_add_f32_dpp v8, v8, v8 row_ror:4 row_mask:0xf bank_mask:0xf
  v_add_f32_dpp v9, v9, v9 row_ror:4 row_mask:0xf bank_mask:0xf
  v_add_f32_dpp v10, v10, v10 row_ror:4 row_mask:0xf bank_mask:0xf
  v_add_f32_dpp v11, v11, v11 row_ror:4 row_mask:0xf bank_mask:0xf
  v_add_f32_dpp v8, v8, v8 row_ror:2 row_mask:0xf bank_mask:0xf
  v_add_f32_dpp v9, v9, v9 row_ror:2 row_mask:0xf bank_mask:0xf
  v_add_f32_dpp v10, v10, v10 row_ror:2 row_mask:0xf bank_mask:0xf
  v_add_f32_dpp v11, v11, v11 row_ror:2 row_mask:0xf bank_mask:0xf
  v_add_f32_dpp v8, v8, v8 row_ror:1 row_mask:0xf bank_mask:0xf
  v_add_f32_dpp v9, v9, v9 row_ror:1 row_mask:0xf bank_mask:0xf
  v_add_f32_dpp v10, v10, v10 row_ror:1 row_mask:0xf bank_mask:0xf
  v_add_f32_dpp v11, v11, v11 row_ror:1 row_mask:0xf bank_mask:0xf
  v_cvt_pk_bf16_f32 v12, v8, v9
  v_cvt_pk_bf16_f32 v13, v10, v11
  v_lshlrev_b32 v8, 16, v12
  v_and_b32 v9, 0xffff0000, v12
  v_lshlrev_b32 v10, 16, v13
  v_and_b32 v11, 0xffff0000, v13
  v_mul_f32 v8, s80, v8
  v_mul_f32 v9, s80, v9
  v_mul_f32 v10, s80, v10
  v_mul_f32 v11, s80, v11
  v_cvt_pk_bf16_f32 v42, v8, v9
  v_cvt_pk_bf16_f32 v43, v10, v11
  v_max3_f32 v4, v4, v8, v9
  v_max3_f32 v4, v4, v10, v11
  s_waitcnt vmcnt(20)
  v_dot2_f32_bf16 v8, v160, v192, 0
  v_dot2_f32_bf16 v9, v164, v192, 0
  v_dot2_f32_bf16 v10, v168, v192, 0
  v_dot2_f32_bf16 v11, v172, v192, 0
  v_dot2_f32_bf16 v8, v161, v193, v8
  v_dot2_f32_bf16 v9, v165, v193, v9
  v_dot2_f32_bf16 v10, v169, v193, v10
  v_dot2_f32_bf16 v11, v173, v193, v11
  v_dot2_f32_bf16 v8, v162, v194, v8
  v_dot2_f32_bf16 v9, v166, v194, v9
  v_dot2_f32_bf16 v10, v170, v194, v10
  v_dot2_f32_bf16 v11, v174, v194, v11
  v_dot2_f32_bf16 v8, v163, v195, v8
  v_dot2_f32_bf16 v9, v167, v195, v9
  v_dot2_f32_bf16 v10, v171, v195, v10
  v_dot2_f32_bf16 v11, v175, v195, v11
  s_nop 2
  v_add_f32_dpp v8, v8, v8 row_ror:8 row_mask:0xf bank_mask:0xf
  v_add_f32_dpp v9, v9, v9 row_ror:8 row_mask:0xf bank_mask:0xf
  v_add_f32_dpp v10, v10, v10 row_ror:8 row_mask:0xf bank_mask:0xf
  v_add_f32_dpp v11, v11, v11 row_ror:8 row_mask:0xf bank_mask:0xf
  v_add_f32_dpp v8, v8, v8 row_ror:4 row_mask:0xf bank_mask:0xf
  v_add_f32_dpp v9, v9, v9 row_ror:4 row_mask:0xf bank_mask:0xf
  v_add_f32_dpp v10, v10, v10 row_ror:4 row_mask:0xf bank_mask:0xf
  v_add_f32_dpp v11, v11, v11 row_ror:4 row_mask:0xf bank_mask:0xf
  v_add_f32_dpp v8, v8, v8 row_ror:2 row_mask:0xf bank_mask:0xf
  v_add_f32_dpp v9, v9, v9 row_ror:2 row_mask:0xf bank_mask:0xf
  v_add_f32_dpp v10, v10, v10 row_ror:2 row_mask:0xf bank_mask:0xf
  v_add_f32_dpp v11, v11, v11 row_ror:2 row_mask:0xf bank_mask:0xf
  v_add_f32_dpp v8, v8, v8 row_ror:1 row_mask:0xf bank_mask:0xf
  v_add_f32_dpp v9, v9, v9 row_ror:1 row_mask:0xf bank_mask:0xf
  v_add_f32_dpp v10, v10, v10 row_ror:1 row_mask:0xf bank_mask:0xf
  v_add_f32_dpp v11, v11, v11 row_ror:1 row_mask:0xf bank_mask:0xf
  v_cvt_pk_bf16_f32 v12, v8, v9
  v_cvt_pk_bf16_f32 v13, v10, v11
  v_lshlrev_b32 v8, 16, v12
  v_and_b32 v9, 0xffff0000, v12
  v_lshlrev_b32 v10, 16, v13
  v_and_b32 v11, 0xffff0000, v13
  v_mul_f32 v8, s80, v8
  v_mul_f32 v9, s80, v9
  v_mul_f32 v10, s80, v10
  v_mul_f32 v11, s80, v11
  v_cvt_pk_bf16_f32 v44, v8, v9
  v_cvt_pk_bf16_f32 v45, v10, v11
  v_max3_f32 v4, v4, v8, v9
  v_max3_f32 v4, v4, v10, v11
  s_waitcnt vmcnt(16)
  v_dot2_f32_bf16 v8, v176, v192, 0
  v_dot2_f32_bf16 v9, v180, v192, 0
  v_dot2_f32_bf16 v10, v184, v192, 0
  v_dot2_f32_bf16 v11, v188, v192, 0
  v_dot2_f32_bf16 v8, v177, v193, v8
  v_dot2_f32_bf16 v9, v181, v193, v9
  v_dot2_f32_bf16 v10, v185, v193, v10
  v_dot2_f32_bf16 v11, v189, v193, v11
  v_dot2_f32_bf16 v8, v178, v194, v8
  v_dot2_f32_bf16 v9, v182, v194, v9
  v_dot2_f32_bf16 v10, v186, v194, v10
  v_dot2_f32_bf16 v11, v190, v194, v11
  v_dot2_f32_bf16 v8, v179, v195, v8
  v_dot2_f32_bf16 v9, v183, v195, v9
  v_dot2_f32_bf16 v10, v187, v195, v10
  v_dot2_f32_bf16 v11, v191, v195, v11
  s_nop 2
  v_add_f32_dpp v8, v8, v8 row_ror:8 row_mask:0xf bank_mask:0xf
  v_add_f32_dpp v9, v9, v9 row_ror:8 row_mask:0xf bank_mask:0xf
  v_add_f32_dpp v10, v10, v10 row_ror:8 row_mask:0xf bank_mask:0xf
  v_add_f32_dpp v11, v11, v11 row_ror:8 row_mask:0xf bank_mask:0xf
  v_add_f32_dpp v8, v8, v8 row_ror:4 row_mask:0xf bank_mask:0xf
  v_add_f32_dpp v9, v9, v9 row_ror:4 row_mask:0xf bank_mask:0xf
  v_add_f32_dpp v10, v10, v10 row_ror:4 row_mask:0xf bank_mask:0xf
  v_add_f32_dpp v11, v11, v11 row_ror:4 row_mask:0xf bank_mask:0xf
  v_add_f32_dpp v8, v8, v8 row_ror:2 row_mask:0xf bank_mask:0xf
  v_add_f32_dpp v9, v9, v9 row_ror:2 row_mask:0xf bank_mask:0xf
  v_add_f32_dpp v10, v10, v10 row_ror:2 row_mask:0xf bank_mask:0xf
  v_add_f32_dpp v11, v11, v11 row_ror:2 row_mask:0xf bank_mask:0xf
  v_add_f32_dpp v8, v8, v8 row_ror:1 row_mask:0xf bank_mask:0xf
  v_add_f32_dpp v9, v9, v9 row_ror:1 row_mask:0xf bank_mask:0xf
  v_add_f32_dpp v10, v10, v10 row_ror:1 row_mask:0xf bank_mask:0xf
  v_add_f32_dpp v11, v11, v11 row_ror:1 row_mask:0xf bank_mask:0xf
  v_cvt_pk_bf16_f32 v12, v8, v9
  v_cvt_pk_bf16_f32 v13, v10, v11
  v_lshlrev_b32 v8, 16, v12
  v_and_b32 v9, 0xffff0000, v12
  v_lshlrev_b32 v10, 16, v13
  v_and_b32 v11, 0xffff0000, v13
  v_mul_f32 v8, s80, v8
  v_mul_f32 v9, s80, v9
  v_mul_f32 v10, s80, v10
  v_mul_f32 v11, s80, v11
  v_cvt_pk_bf16_f32 v46, v8, v9
  v_cvt_pk_bf16_f32 v47, v10, v11
  v_max3_f32 v4, v4, v8, v9
  v_max3_f32 v4, v4, v10, v11
  s_waitcnt vmcnt(12)
  v_dot2_f32_bf16 v8, v64, v192, 0
  v_dot2_f32_bf16 v9, v68, v192, 0
  v_dot2_f32_bf16 v10, v72, v192, 0
  v_dot2_f32_bf16 v11, v76, v192, 0
  v_dot2_f32_bf16 v8, v65, v193, v8
  v_dot2_f32_bf16 v9, v69, v193, v9
  v_dot2_f32_bf16 v10, v73, v193, v10
  v_dot2_f32_bf16 v11, v77, v193, v11
  v_dot2_f32_bf16 v8, v66, v194, v8
  v_dot2_f32_bf16 v9, v70, v194, v9
  v_dot2_f32_bf16 v10, v74, v194, v10
  v_dot2_f32_bf16 v11, v78, v194, v11
  v_dot2_f32_bf16 v8, v67, v195, v8
  v_dot2_f32_bf16 v9, v71, v195, v9
  v_dot2_f32_bf16 v10, v75, v195, v10
  v_dot2_f32_bf16 v11, v79, v195, v11
  s_add_u32 s65, s64, 196608
  buffer_load_dwordx4 v[64:67], v2, s[24:27], s65 offen offset:0 nt
  buffer_load_dwordx4 v[68:71], v2, s[24:27], s65 offen offset:1024 nt
  buffer_load_dwordx4 v[72:75], v2, s[24:27], s65 offen offset:2048 nt
  buffer_load_dwordx4 v[76:79], v2, s[24:27], s65 offen offset:3072 nt
  s_add_u32 s65, s72, 0
  buffer_load_dwordx4 v[128:131], v227, s[36:39], s65 offen offset:0
  v_add_f32_dpp v8, v8, v8 row_ror:8 row_mask:0xf bank_mask:0xf
  v_add_f32_dpp v9, v9, v9 row_ror:8 row_mask:0xf bank_mask:0xf
  v_add_f32_dpp v10, v10, v10 row_ror:8 row_mask:0xf bank_mask:0xf
  v_add_f32_dpp v11, v11, v11 row_ror:8 row_mask:0xf bank_mask:0xf
  v_add_f32_dpp v8, v8, v8 row_ror:4 row_mask:0xf bank_mask:0xf
  v_add_f32_dpp v9, v9, v9 row_ror:4 row_mask:0xf bank_mask:0xf
  v_add_f32_dpp v10, v10, v10 row_ror:4 row_mask:0xf bank_mask:0xf
  v_add_f32_dpp v11, v11, v11 row_ror:4 row_mask:0xf bank_mask:0xf
  v_add_f32_dpp v8, v8, v8 row_ror:2 row_mask:0xf bank_mask:0xf
  v_add_f32_dpp v9, v9, v9 row_ror:2 row_mask:0xf bank_mask:0xf
  v_add_f32_dpp v10, v10, v10 row_ror:2 row_mask:0xf bank_mask:0xf
  v_add_f32_dpp v11, v11, v11 row_ror:2 row_mask:0xf bank_mask:0xf
  v_add_f32_dpp v8, v8, v8 row_ror:1 row_mask:0xf bank_mask:0xf
  v_add_f32_dpp v9, v9, v9 row_ror:1 row_mask:0xf bank_mask:0xf
  v_add_f32_dpp v10, v10, v10 row_ror:1 row_mask:0xf bank_mask:0xf
  v_add_f32_dpp v11, v11, v11 row_ror:1 row_mask:0xf bank_mask:0xf
  v_cvt_pk_bf16_f32 v12, v8, v9
  v_cvt_pk_bf16_f32 v13, v10, v11
  v_lshlrev_b32 v8, 16, v12
  v_and_b32 v9, 0xffff0000, v12
  v_lshlrev_b32 v10, 16, v13
  v_and_b32 v11, 0xffff0000, v13
  v_mul_f32 v8, s80, v8
  v_mul_f32 v9, s80, v9
  v_mul_f32 v10, s80, v10
  v_mul_f32 v11, s80, v11
  v_cvt_pk_bf16_f32 v48, v8, v9
  v_cvt_pk_bf16_f32 v49, v10, v11
  v_max3_f32 v4, v4, v8, v9
  v_max3_f32 v4, v4, v10, v11
  s_waitcnt vmcnt(13)
  v_dot2_f32_bf16 v8, v80, v192, 0
  v_dot2_f32_bf16 v9, v84, v192, 0
  v_dot2_f32_bf16 v10, v88, v192, 0
  v_dot2_f32_bf16 v11, v92, v192, 0
  v_dot2_f32_bf16 v8, v81, v193, v8
  v_dot2_f32_bf16 v9, v85, v193, v9
  v_dot2_f32_bf16 v10, v89, v193, v10
  v_dot2_f32_bf16 v11, v93, v193, v11
  v_dot2_f32_bf16 v8, v82, v194, v8
  v_dot2_f32_bf16 v9, v86, v194, v9
  v_dot2_f32_bf16 v10, v90, v194, v10
  v_dot2_f32_bf16 v11, v94, v194, v11
  v_dot2_f32_bf16 v8, v83, v195, v8
  v_dot2_f32_bf16 v9, v87, v195, v9
  v_dot2_f32_bf16 v10, v91, v195, v10
  v_dot2_f32_bf16 v11, v95, v195, v11
  s_add_u32 s65, s64, 212992
  buffer_load_dwordx4 v[80:83], v2, s[24:27], s65 offen offset:0 nt
  buffer_load_dwordx4 v[84:87], v2, s[24:27], s65 offen offset:1024 nt
  buffer_load_dwordx4 v[88:91], v2, s[24:27], s65 offen offset:2048 nt
  buffer_load_dwordx4 v[92:95], v2, s[24:27], s65 offen offset:3072 nt
  s_add_u32 s65, s72, 0
  buffer_load_dwordx4 v[132:135], v227, s[36:39], s65 offen offset:256
  v_add_f32_dpp v8, v8, v8 row_ror:8 row_mask:0xf bank_mask:0xf
  v_add_f32_dpp v9, v9, v9 row_ror:8 row_mask:0xf bank_mask:0xf
  v_add_f32_dpp v10, v10, v10 row_ror:8 row_mask:0xf bank_mask:0xf
  v_add_f32_dpp v11, v11, v11 row_ror:8 row_mask:0xf bank_mask:0xf
  v_add_f32_dpp v8, v8, v8 row_ror:4 row_mask:0xf bank_mask:0xf
  v_add_f32_dpp v9, v9, v9 row_ror:4 row_mask:0xf bank_mask:0xf
  v_add_f32_dpp v10, v10, v10 row_ror:4 row_mask:0xf bank_mask:0xf
  v_add_f32_dpp v11, v11, v11 row_ror:4 row_mask:0xf bank_mask:0xf
  v_add_f32_dpp v8, v8, v8 row_ror:2 row_mask:0xf bank_mask:0xf
  v_add_f32_dpp v9, v9, v9 row_ror:2 row_mask:0xf bank_mask:0xf
  v_add_f32_dpp v10, v10, v10 row_ror:2 row_mask:0xf bank_mask:0xf
  v_add_f32_dpp v11, v11, v11 row_ror:2 row_mask:0xf bank_mask:0xf
  v_add_f32_dpp v8, v8, v8 row_ror:1 row_mask:0xf bank_mask:0xf
  v_add_f32_dpp v9, v9, v9 row_ror:1 row_mask:0xf bank_mask:0xf
  v_add_f32_dpp v10, v10, v10 row_ror:1 row_mask:0xf bank_mask:0xf
  v_add_f32_dpp v11, v11, v11 row_ror:1 row_mask:0xf bank_mask:0xf
  v_cvt_pk_bf16_f32 v12, v8, v9
  v_cvt_pk_bf16_f32 v13, v10, v11
  v_lshlrev_b32 v8, 16, v12
  v_and_b32 v9, 0xffff0000, v12
  v_lshlrev_b32 v10, 16, v13
  v_and_b32 v11, 0xffff0000, v13
  v_mul_f32 v8, s80, v8
  v_mul_f32 v9, s80, v9
  v_mul_f32 v10, s80, v10
  v_mul_f32 v11, s80, v11
  v_cvt_pk_bf16_f32 v50, v8, v9
  v_cvt_pk_bf16_f32 v51, v10, v11
  v_max3_f32 v4, v4, v8, v9
  v_max3_f32 v4, v4, v10, v11
  s_waitcnt vmcnt(14)
  v_dot2_f32_bf16 v8, v96, v192, 0
  v_dot2_f32_bf16 v9, v100, v192, 0
  v_dot2_f32_bf16 v10, v104, v192, 0
  v_dot2_f32_bf16 v11, v108, v192, 0
  v_dot2_f32_bf16 v8, v97, v193, v8
  v_dot2_f32_bf16 v9, v101, v193, v9
  v_dot2_f32_bf16 v10, v105, v193, v10
  v_dot2_f32_bf16 v11, v109, v193, v11
  v_dot2_f32_bf16 v8, v98, v194, v8
  v_dot2_f32_bf16 v9, v102, v194, v9
  v_dot2_f32_bf16 v10, v106, v194, v10
  v_dot2_f32_bf16 v11, v110, v194, v11
  v_dot2_f32_bf16 v8, v99, v195, v8
  v_dot2_f32_bf16 v9, v103, v195, v9
  v_dot2_f32_bf16 v10, v107, v195, v10
  v_dot2_f32_bf16 v11, v111, v195, v11
  s_add_u32 s65, s64, 229376
  buffer_load_dwordx4 v[96:99], v2, s[24:27], s65 offen offset:0 nt
  buffer_load_dwordx4 v[100:103], v2, s[24:27], s65 offen offset:1024 nt
  buffer_load_dwordx4 v[104:107], v2, s[24:27], s65 offen offset:2048 nt
  buffer_load_dwordx4 v[108:111], v2, s[24:27], s65 offen offset:3072 nt
  s_add_u32 s65, s72, 0
  buffer_load_dwordx4 v[136:139], v227, s[36:39], s65 offen offset:512
  v_add_f32_dpp v8, v8, v8 row_ror:8 row_mask:0xf bank_mask:0xf
  v_add_f32_dpp v9, v9, v9 row_ror:8 row_mask:0xf bank_mask:0xf
  v_add_f32_dpp v10, v10, v10 row_ror:8 row_mask:0xf bank_mask:0xf
  v_add_f32_dpp v11, v11, v11 row_ror:8 row_mask:0xf bank_mask:0xf
  v_add_f32_dpp v8, v8, v8 row_ror:4 row_mask:0xf bank_mask:0xf
  v_add_f32_dpp v9, v9, v9 row_ror:4 row_mask:0xf bank_mask:0xf
  v_add_f32_dpp v10, v10, v10 row_ror:4 row_mask:0xf bank_mask:0xf
  v_add_f32_dpp v11, v11, v11 row_ror:4 row_mask:0xf bank_mask:0xf
  v_add_f32_dpp v8, v8, v8 row_ror:2 row_mask:0xf bank_mask:0xf
  v_add_f32_dpp v9, v9, v9 row_ror:2 row_mask:0xf bank_mask:0xf
  v_add_f32_dpp v10, v10, v10 row_ror:2 row_mask:0xf bank_mask:0xf
  v_add_f32_dpp v11, v11, v11 row_ror:2 row_mask:0xf bank_mask:0xf
  v_add_f32_dpp v8, v8, v8 row_ror:1 row_mask:0xf bank_mask:0xf
  v_add_f32_dpp v9, v9, v9 row_ror:1 row_mask:0xf bank_mask:0xf
  v_add_f32_dpp v10, v10, v10 row_ror:1 row_mask:0xf bank_mask:0xf
  v_add_f32_dpp v11, v11, v11 row_ror:1 row_mask:0xf bank_mask:0xf
  v_cvt_pk_bf16_f32 v12, v8, v9
  v_cvt_pk_bf16_f32 v13, v10, v11
  v_lshlrev_b32 v8, 16, v12
  v_and_b32 v9, 0xffff0000, v12
  v_lshlrev_b32 v10, 16, v13
  v_and_b32 v11, 0xffff0000, v13
  v_mul_f32 v8, s80, v8
  v_mul_f32 v9, s80, v9
  v_mul_f32 v10, s80, v10
  v_mul_f32 v11, s80, v11
  v_cvt_pk_bf16_f32 v52, v8, v9
  v_cvt_pk_bf16_f32 v53, v10, v11
  v_max3_f32 v4, v4, v8, v9
  v_max3_f32 v4, v4, v10, v11
  s_waitcnt vmcnt(15)
  v_dot2_f32_bf16 v8, v112, v192, 0
  v_dot2_f32_bf16 v9, v116, v192, 0
  v_dot2_f32_bf16 v10, v120, v192, 0
  v_dot2_f32_bf16 v11, v124, v192, 0
  v_dot2_f32_bf16 v8, v113, v193, v8
  v_dot2_f32_bf16 v9, v117, v193, v9
  v_dot2_f32_bf16 v10, v121, v193, v10
  v_dot2_f32_bf16 v11, v125, v193, v11
  v_dot2_f32_bf16 v8, v114, v194, v8
  v_dot2_f32_bf16 v9, v118, v194, v9
  v_dot2_f32_bf16 v10, v122, v194, v10
  v_dot2_f32_bf16 v11, v126, v194, v11
  v_dot2_f32_bf16 v8, v115, v195, v8
  v_dot2_f32_bf16 v9, v119, v195, v9
  v_dot2_f32_bf16 v10, v123, v195, v10
  v_dot2_f32_bf16 v11, v127, v195, v11
  s_add_u32 s65, s64, 245760
  buffer_load_dwordx4 v[112:115], v2, s[24:27], s65 offen offset:0 nt
  buffer_load_dwordx4 v[116:119], v2, s[24:27], s65 offen offset:1024 nt
  buffer_load_dwordx4 v[120:123], v2, s[24:27], s65 offen offset:2048 nt
  buffer_load_dwordx4 v[124:127], v2, s[24:27], s65 offen offset:3072 nt
  s_add_u32 s65, s72, 0
  buffer_load_dwordx4 v[140:143], v227, s[36:39], s65 offen offset:768
  v_add_f32_dpp v8, v8, v8 row_ror:8 row_mask:0xf bank_mask:0xf
  v_add_f32_dpp v9, v9, v9 row_ror:8 row_mask:0xf bank_mask:0xf
  v_add_f32_dpp v10, v10, v10 row_ror:8 row_mask:0xf bank_mask:0xf
  v_add_f32_dpp v11, v11, v11 row_ror:8 row_mask:0xf bank_mask:0xf
  v_add_f32_dpp v8, v8, v8 row_ror:4 row_mask:0xf bank_mask:0xf
  v_add_f32_dpp v9, v9, v9 row_ror:4 row_mask:0xf bank_mask:0xf
  v_add_f32_dpp v10, v10, v10 row_ror:4 row_mask:0xf bank_mask:0xf
  v_add_f32_dpp v11, v11, v11 row_ror:4 row_mask:0xf bank_mask:0xf
  v_add_f32_dpp v8, v8, v8 row_ror:2 row_mask:0xf bank_mask:0xf
  v_add_f32_dpp v9, v9, v9 row_ror:2 row_mask:0xf bank_mask:0xf
  v_add_f32_dpp v10, v10, v10 row_ror:2 row_mask:0xf bank_mask:0xf
  v_add_f32_dpp v11, v11, v11 row_ror:2 row_mask:0xf bank_mask:0xf
  v_add_f32_dpp v8, v8, v8 row_ror:1 row_mask:0xf bank_mask:0xf
  v_add_f32_dpp v9, v9, v9 row_ror:1 row_mask:0xf bank_mask:0xf
  v_add_f32_dpp v10, v10, v10 row_ror:1 row_mask:0xf bank_mask:0xf
  v_add_f32_dpp v11, v11, v11 row_ror:1 row_mask:0xf bank_mask:0xf
  v_cvt_pk_bf16_f32 v12, v8, v9
  v_cvt_pk_bf16_f32 v13, v10, v11
  v_lshlrev_b32 v8, 16, v12
  v_and_b32 v9, 0xffff0000, v12
  v_lshlrev_b32 v10, 16, v13
  v_and_b32 v11, 0xffff0000, v13
  v_mul_f32 v8, s80, v8
  v_mul_f32 v9, s80, v9
  v_mul_f32 v10, s80, v10
  v_mul_f32 v11, s80, v11
  v_cvt_pk_bf16_f32 v54, v8, v9
  v_cvt_pk_bf16_f32 v55, v10, v11
  v_max3_f32 v4, v4, v8, v9
  v_max3_f32 v4, v4, v10, v11
  s_waitcnt vmcnt(16)
  v_dot2_f32_bf16 v8, v64, v192, 0
  v_dot2_f32_bf16 v9, v68, v192, 0
  v_dot2_f32_bf16 v10, v72, v192, 0
  v_dot2_f32_bf16 v11, v76, v192, 0
  v_dot2_f32_bf16 v8, v65, v193, v8
  v_dot2_f32_bf16 v9, v69, v193, v9
  v_dot2_f32_bf16 v10, v73, v193, v10
  v_dot2_f32_bf16 v11, v77, v193, v11
  v_dot2_f32_bf16 v8, v66, v194, v8
  v_dot2_f32_bf16 v9, v70, v194, v9
  v_dot2_f32_bf16 v10, v74, v194, v10
  v_dot2_f32_bf16 v11, v78, v194, v11
  v_dot2_f32_bf16 v8, v67, v195, v8
  v_dot2_f32_bf16 v9, v71, v195, v9
  v_dot2_f32_bf16 v10, v75, v195, v10
  v_dot2_f32_bf16 v11, v79, v195, v11
  s_add_u32 s65, s64, 0
  buffer_load_dwordx4 v[64:67], v2, s[28:31], s65 offen offset:0 nt
  buffer_load_dwordx4 v[68:71], v2, s[28:31], s65 offen offset:1024 nt
  buffer_load_dwordx4 v[72:75], v2, s[28:31], s65 offen offset:2048 nt
  buffer_load_dwordx4 v[76:79], v2, s[28:31], s65 offen offset:3072 nt
  s_add_u32 s65, s72, 1024
  buffer_load_dwordx4 v[144:147], v227, s[36:39], s65 offen offset:0
  v_add_f32_dpp v8, v8, v8 row_ror:8 row_mask:0xf bank_mask:0xf
  v_add_f32_dpp v9, v9, v9 row_ror:8 row_mask:0xf bank_mask:0xf
  v_add_f32_dpp v10, v10, v10 row_ror:8 row_mask:0xf bank_mask:0xf
  v_add_f32_dpp v11, v11, v11 row_ror:8 row_mask:0xf bank_mask:0xf
  v_add_f32_dpp v8, v8, v8 row_ror:4 row_mask:0xf bank_mask:0xf
  v_add_f32_dpp v9, v9, v9 row_ror:4 row_mask:0xf bank_mask:0xf
  v_add_f32_dpp v10, v10, v10 row_ror:4 row_mask:0xf bank_mask:0xf
  v_add_f32_dpp v11, v11, v11 row_ror:4 row_mask:0xf bank_mask:0xf
  v_add_f32_dpp v8, v8, v8 row_ror:2 row_mask:0xf bank_mask:0xf
  v_add_f32_dpp v9, v9, v9 row_ror:2 row_mask:0xf bank_mask:0xf
  v_add_f32_dpp v10, v10, v10 row_ror:2 row_mask:0xf bank_mask:0xf
  v_add_f32_dpp v11, v11, v11 row_ror:2 row_mask:0xf bank_mask:0xf
  v_add_f32_dpp v8, v8, v8 row_ror:1 row_mask:0xf bank_mask:0xf
  v_add_f32_dpp v9, v9, v9 row_ror:1 row_mask:0xf bank_mask:0xf
  v_add_f32_dpp v10, v10, v10 row_ror:1 row_mask:0xf bank_mask:0xf
  v_add_f32_dpp v11, v11, v11 row_ror:1 row_mask:0xf bank_mask:0xf
  v_cvt_pk_bf16_f32 v12, v8, v9
  v_cvt_pk_bf16_f32 v13, v10, v11
  v_lshlrev_b32 v8, 16, v12
  v_and_b32 v9, 0xffff0000, v12
  v_lshlrev_b32 v10, 16, v13
  v_and_b32 v11, 0xffff0000, v13
  v_mul_f32 v8, s80, v8
  v_mul_f32 v9, s80, v9
  v_mul_f32 v10, s80, v10
  v_mul_f32 v11, s80, v11
  v_cvt_pk_bf16_f32 v56, v8, v9
  v_cvt_pk_bf16_f32 v57, v10, v11
  v_max3_f32 v4, v4, v8, v9
  v_max3_f32 v4, v4, v10, v11
  s_waitcnt vmcnt(16)
  v_dot2_f32_bf16 v8, v80, v192, 0
  v_dot2_f32_bf16 v9, v84, v192, 0
  v_dot2_f32_bf16 v10, v88, v192, 0
  v_dot2_f32_bf16 v11, v92, v192, 0
  v_dot2_f32_bf16 v8, v81, v193, v8
  v_dot2_f32_bf16 v9, v85, v193, v9
  v_dot2_f32_bf16 v10, v89, v193, v10
  v_dot2_f32_bf16 v11, v93, v193, v11
  v_dot2_f32_bf16 v8, v82, v194, v8
  v_dot2_f32_bf16 v9, v86, v194, v9
  v_dot2_f32_bf16 v10, v90, v194, v10
  v_dot2_f32_bf16 v11, v94, v194, v11
  v_dot2_f32_bf16 v8, v83, v195, v8
  v_dot2_f32_bf16 v9, v87, v195, v9
  v_dot2_f32_bf16 v10, v91, v195, v10
  v_dot2_f32_bf16 v11, v95, v195, v11
  s_add_u32 s65, s64, 16384
  buffer_load_dwordx4 v[80:83], v2, s[28:31], s65 offen offset:0 nt
  buffer_load_dwordx4 v[84:87], v2, s[28:31], s65 offen offset:1024 nt
  buffer_load_dwordx4 v[88:91], v2, s[28:31], s65 offen offset:2048 nt
  buffer_load_dwordx4 v[92:95], v2, s[28:31], s65 offen offset:3072 nt
  s_add_u32 s65, s72, 1024
  buffer_load_dwordx4 v[148:151], v227, s[36:39], s65 offen offset:256
  v_add_f32_dpp v8, v8, v8 row_ror:8 row_mask:0xf bank_mask:0xf
  v_add_f32_dpp v9, v9, v9 row_ror:8 row_mask:0xf bank_mask:0xf
  v_add_f32_dpp v10, v10, v10 row_ror:8 row_mask:0xf bank_mask:0xf
  v_add_f32_dpp v11, v11, v11 row_ror:8 row_mask:0xf bank_mask:0xf
  v_add_f32_dpp v8, v8, v8 row_ror:4 row_mask:0xf bank_mask:0xf
  v_add_f32_dpp v9, v9, v9 row_ror:4 row_mask:0xf bank_mask:0xf
  v_add_f32_dpp v10, v10, v10 row_ror:4 row_mask:0xf bank_mask:0xf
  v_add_f32_dpp v11, v11, v11 row_ror:4 row_mask:0xf bank_mask:0xf
  v_add_f32_dpp v8, v8, v8 row_ror:2 row_mask:0xf bank_mask:0xf
  v_add_f32_dpp v9, v9, v9 row_ror:2 row_mask:0xf bank_mask:0xf
  v_add_f32_dpp v10, v10, v10 row_ror:2 row_mask:0xf bank_mask:0xf
  v_add_f32_dpp v11, v11, v11 row_ror:2 row_mask:0xf bank_mask:0xf
  v_add_f32_dpp v8, v8, v8 row_ror:1 row_mask:0xf bank_mask:0xf
  v_add_f32_dpp v9, v9, v9 row_ror:1 row_mask:0xf bank_mask:0xf
  v_add_f32_dpp v10, v10, v10 row_ror:1 row_mask:0xf bank_mask:0xf
  v_add_f32_dpp v11, v11, v11 row_ror:1 row_mask:0xf bank_mask:0xf
  v_cvt_pk_bf16_f32 v12, v8, v9
  v_cvt_pk_bf16_f32 v13, v10, v11
  v_lshlrev_b32 v8, 16, v12
  v_and_b32 v9, 0xffff0000, v12
  v_lshlrev_b32 v10, 16, v13
  v_and_b32 v11, 0xffff0000, v13
  v_mul_f32 v8, s80, v8
  v_mul_f32 v9, s80, v9
  v_mul_f32 v10, s80, v10
  v_mul_f32 v11, s80, v11
  v_cvt_pk_bf16_f32 v58, v8, v9
  v_cvt_pk_bf16_f32 v59, v10, v11
  v_max3_f32 v4, v4, v8, v9
  v_max3_f32 v4, v4, v10, v11
  s_waitcnt vmcnt(16)
  v_dot2_f32_bf16 v8, v96, v192, 0
  v_dot2_f32_bf16 v9, v100, v192, 0
  v_dot2_f32_bf16 v10, v104, v192, 0
  v_dot2_f32_bf16 v11, v108, v192, 0
  v_dot2_f32_bf16 v8, v97, v193, v8
  v_dot2_f32_bf16 v9, v101, v193, v9
  v_dot2_f32_bf16 v10, v105, v193, v10
  v_dot2_f32_bf16 v11, v109, v193, v11
  v_dot2_f32_bf16 v8, v98, v194, v8
  v_dot2_f32_bf16 v9, v102, v194, v9
  v_dot2_f32_bf16 v10, v106, v194, v10
  v_dot2_f32_bf16 v11, v110, v194, v11
  v_dot2_f32_bf16 v8, v99, v195, v8
  v_dot2_f32_bf16 v9, v103, v195, v9
  v_dot2_f32_bf16 v10, v107, v195, v10
  v_dot2_f32_bf16 v11, v111, v195, v11
  s_add_u32 s65, s64, 32768
  buffer_load_dwordx4 v[96:99], v2, s[28:31], s65 offen offset:0 nt
  buffer_load_dwordx4 v[100:103], v2, s[28:31], s65 offen offset:1024 nt
  buffer_load_dwordx4 v[104:107], v2, s[28:31], s65 offen offset:2048 nt
  buffer_load_dwordx4 v[108:111], v2, s[28:31], s65 offen offset:3072 nt
  s_add_u32 s65, s72, 1024
  buffer_load_dwordx4 v[152:155], v227, s[36:39], s65 offen offset:512
  v_add_f32_dpp v8, v8, v8 row_ror:8 row_mask:0xf bank_mask:0xf
  v_add_f32_dpp v9, v9, v9 row_ror:8 row_mask:0xf bank_mask:0xf
  v_add_f32_dpp v10, v10, v10 row_ror:8 row_mask:0xf bank_mask:0xf
  v_add_f32_dpp v11, v11, v11 row_ror:8 row_mask:0xf bank_mask:0xf
  v_add_f32_dpp v8, v8, v8 row_ror:4 row_mask:0xf bank_mask:0xf
  v_add_f32_dpp v9, v9, v9 row_ror:4 row_mask:0xf bank_mask:0xf
  v_add_f32_dpp v10, v10, v10 row_ror:4 row_mask:0xf bank_mask:0xf
  v_add_f32_dpp v11, v11, v11 row_ror:4 row_mask:0xf bank_mask:0xf
  v_add_f32_dpp v8, v8, v8 row_ror:2 row_mask:0xf bank_mask:0xf
  v_add_f32_dpp v9, v9, v9 row_ror:2 row_mask:0xf bank_mask:0xf
  v_add_f32_dpp v10, v10, v10 row_ror:2 row_mask:0xf bank_mask:0xf
  v_add_f32_dpp v11, v11, v11 row_ror:2 row_mask:0xf bank_mask:0xf
  v_add_f32_dpp v8, v8, v8 row_ror:1 row_mask:0xf bank_mask:0xf
  v_add_f32_dpp v9, v9, v9 row_ror:1 row_mask:0xf bank_mask:0xf
  v_add_f32_dpp v10, v10, v10 row_ror:1 row_mask:0xf bank_mask:0xf
  v_add_f32_dpp v11, v11, v11 row_ror:1 row_mask:0xf bank_mask:0xf
  v_cvt_pk_bf16_f32 v12, v8, v9
  v_cvt_pk_bf16_f32 v13, v10, v11
  v_lshlrev_b32 v8, 16, v12
  v_and_b32 v9, 0xffff0000, v12
  v_lshlrev_b32 v10, 16, v13
  v_and_b32 v11, 0xffff0000, v13
  v_mul_f32 v8, s80, v8
  v_mul_f32 v9, s80, v9
  v_mul_f32 v10, s80, v10
  v_mul_f32 v11, s80, v11
  v_cvt_pk_bf16_f32 v60, v8, v9
  v_cvt_pk_bf16_f32 v61, v10, v11
  v_max3_f32 v4, v4, v8, v9
  v_max3_f32 v4, v4, v10, v11
  s_waitcnt vmcnt(16)
  v_dot2_f32_bf16 v8, v112, v192, 0
  v_dot2_f32_bf16 v9, v116, v192, 0
  v_dot2_f32_bf16 v10, v120, v192, 0
  v_dot2_f32_bf16 v11, v124, v192, 0
  v_dot2_f32_bf16 v8, v113, v193, v8
  v_dot2_f32_bf16 v9, v117, v193, v9
  v_dot2_f32_bf16 v10, v121, v193, v10
  v_dot2_f32_bf16 v11, v125, v193, v11
  v_dot2_f32_bf16 v8, v114, v194, v8
  v_dot2_f32_bf16 v9, v118, v194, v9
  v_dot2_f32_bf16 v10, v122, v194, v10
  v_dot2_f32_bf16 v11, v126, v194, v11
  v_dot2_f32_bf16 v8, v115, v195, v8
  v_dot2_f32_bf16 v9, v119, v195, v9
  v_dot2_f32_bf16 v10, v123, v195, v10
  v_dot2_f32_bf16 v11, v127, v195, v11
  s_add_u32 s65, s64, 49152
  buffer_load_dwordx4 v[112:115], v2, s[28:31], s65 offen offset:0 nt
  buffer_load_dwordx4 v[116:119], v2, s[28:31], s65 offen offset:1024 nt
  buffer_load_dwordx4 v[120:123], v2, s[28:31], s65 offen offset:2048 nt
  buffer_load_dwordx4 v[124:127], v2, s[28:31], s65 offen offset:3072 nt
  s_add_u32 s65, s72, 1024
  buffer_load_dwordx4 v[156:159], v227, s[36:39], s65 offen offset:768
  v_add_f32_dpp v8, v8, v8 row_ror:8 row_mask:0xf bank_mask:0xf
  v_add_f32_dpp v9, v9, v9 row_ror:8 row_mask:0xf bank_mask:0xf
  v_add_f32_dpp v10, v10, v10 row_ror:8 row_mask:0xf bank_mask:0xf
  v_add_f32_dpp v11, v11, v11 row_ror:8 row_mask:0xf bank_mask:0xf
  v_add_f32_dpp v8, v8, v8 row_ror:4 row_mask:0xf bank_mask:0xf
  v_add_f32_dpp v9, v9, v9 row_ror:4 row_mask:0xf bank_mask:0xf
  v_add_f32_dpp v10, v10, v10 row_ror:4 row_mask:0xf bank_mask:0xf
  v_add_f32_dpp v11, v11, v11 row_ror:4 row_mask:0xf bank_mask:0xf
  v_add_f32_dpp v8, v8, v8 row_ror:2 row_mask:0xf bank_mask:0xf
  v_add_f32_dpp v9, v9, v9 row_ror:2 row_mask:0xf bank_mask:0xf
  v_add_f32_dpp v10, v10, v10 row_ror:2 row_mask:0xf bank_mask:0xf
  v_add_f32_dpp v11, v11, v11 row_ror:2 row_mask:0xf bank_mask:0xf
  v_add_f32_dpp v8, v8, v8 row_ror:1 row_mask:0xf bank_mask:0xf
  v_add_f32_dpp v9, v9, v9 row_ror:1 row_mask:0xf bank_mask:0xf
  v_add_f32_dpp v10, v10, v10 row_ror:1 row_mask:0xf bank_mask:0xf
  v_add_f32_dpp v11, v11, v11 row_ror:1 row_mask:0xf bank_mask:0xf
  v_cvt_pk_bf16_f32 v12, v8, v9
  v_cvt_pk_bf16_f32 v13, v10, v11
  v_lshlrev_b32 v8, 16, v12
  v_and_b32 v9, 0xffff0000, v12
  v_lshlrev_b32 v10, 16, v13
  v_and_b32 v11, 0xffff0000, v13
  v_mul_f32 v8, s80, v8
  v_mul_f32 v9, s80, v9
  v_mul_f32 v10, s80, v10
  v_mul_f32 v11, s80, v11
  v_cvt_pk_bf16_f32 v62, v8, v9
  v_cvt_pk_bf16_f32 v63, v10, v11
  v_max3_f32 v4, v4, v8, v9
  v_max3_f32 v4, v4, v10, v11
  v_mov_b32 v7, v4
  s_nop 1
  v_permlane16_swap_b32 v4, v7
  v_max_f32 v4, v4, v7
  v_mov_b32 v7, v4
  s_nop 1
  v_permlane32_swap_b32 v4, v7
  v_max_f32 v4, v4, v7
  v_cvt_pk_bf16_f32 v4, v4, v4
  v_lshlrev_b32 v4, 16, v4
  v_mul_f32 v6, s81, v4
  v_sub_f32 v6, 0, v6
  v_mov_b32 v5, 0
  v_lshlrev_b32 v8, 16, v32
  v_and_b32 v9, 0xffff0000, v32
  v_lshlrev_b32 v10, 16, v33
  v_and_b32 v11, 0xffff0000, v33
  v_fma_f32 v8, v8, s81, v6
  v_fma_f32 v9, v9, s81, v6
  v_fma_f32 v10, v10, s81, v6
  v_fma_f32 v11, v11, s81, v6
  v_exp_f32 v8, v8
  v_exp_f32 v9, v9
  v_exp_f32 v10, v10
  v_exp_f32 v11, v11
  s_nop 0
  v_cvt_pk_bf16_f32 v32, v8, v9
  v_cvt_pk_bf16_f32 v33, v10, v11
  v_add_f32 v8, v8, v9
  v_add_f32 v10, v10, v11
  v_add_f32 v5, v5, v8
  v_add_f32 v5, v5, v10
  v_lshlrev_b32 v8, 16, v34
  v_and_b32 v9, 0xffff0000, v34
  v_lshlrev_b32 v10, 16, v35
  v_and_b32 v11, 0xffff0000, v35
  v_fma_f32 v8, v8, s81, v6
  v_fma_f32 v9, v9, s81, v6
  v_fma_f32 v10, v10, s81, v6
  v_fma_f32 v11, v11, s81, v6
  v_exp_f32 v8, v8
  v_exp_f32 v9, v9
  v_exp_f32 v10, v10
  v_exp_f32 v11, v11
  s_nop 0
  v_cvt_pk_bf16_f32 v34, v8, v9
  v_cvt_pk_bf16_f32 v35, v10, v11
  v_add_f32 v8, v8, v9
  v_add_f32 v10, v10, v11
  v_add_f32 v5, v5, v8
  v_add_f32 v5, v5, v10
  v_lshlrev_b32 v8, 16, v36
  v_and_b32 v9, 0xffff0000, v36
  v_lshlrev_b32 v10, 16, v37
  v_and_b32 v11, 0xffff0000, v37
  v_fma_f32 v8, v8, s81, v6
  v_fma_f32 v9, v9, s81, v6
  v_fma_f32 v10, v10, s81, v6
  v_fma_f32 v11, v11, s81, v6
  v_exp_f32 v8, v8
  v_exp_f32 v9, v9
  v_exp_f32 v10, v10
  v_exp_f32 v11, v11
  s_nop 0
  v_cvt_pk_bf16_f32 v36, v8, v9
  v_cvt_pk_bf16_f32 v37, v10, v11
  v_add_f32 v8, v8, v9
  v_add_f32 v10, v10, v11
  v_add_f32 v5, v5, v8
  v_add_f32 v5, v5, v10
  v_lshlrev_b32 v8, 16, v38
  v_and_b32 v9, 0xffff0000, v38
  v_lshlrev_b32 v10, 16, v39
  v_and_b32 v11, 0xffff0000, v39
  v_fma_f32 v8, v8, s81, v6
  v_fma_f32 v9, v9, s81, v6
  v_fma_f32 v10, v10, s81, v6
  v_fma_f32 v11, v11, s81, v6
  v_exp_f32 v8, v8
  v_exp_f32 v9, v9
  v_exp_f32 v10, v10
  v_exp_f32 v11, v11
  s_nop 0
  v_cvt_pk_bf16_f32 v38, v8, v9
  v_cvt_pk_bf16_f32 v39, v10, v11
  v_add_f32 v8, v8, v9
  v_add_f32 v10, v10, v11
  v_add_f32 v5, v5, v8
  v_add_f32 v5, v5, v10
  v_lshlrev_b32 v8, 16, v40
  v_and_b32 v9, 0xffff0000, v40
  v_lshlrev_b32 v10, 16, v41
  v_and_b32 v11, 0xffff0000, v41
  v_fma_f32 v8, v8, s81, v6
  v_fma_f32 v9, v9, s81, v6
  v_fma_f32 v10, v10, s81, v6
  v_fma_f32 v11, v11, s81, v6
  v_exp_f32 v8, v8
  v_exp_f32 v9, v9
  v_exp_f32 v10, v10
  v_exp_f32 v11, v11
  s_nop 0
  v_cvt_pk_bf16_f32 v40, v8, v9
  v_cvt_pk_bf16_f32 v41, v10, v11
  v_add_f32 v8, v8, v9
  v_add_f32 v10, v10, v11
  v_add_f32 v5, v5, v8
  v_add_f32 v5, v5, v10
  v_lshlrev_b32 v8, 16, v42
  v_and_b32 v9, 0xffff0000, v42
  v_lshlrev_b32 v10, 16, v43
  v_and_b32 v11, 0xffff0000, v43
  v_fma_f32 v8, v8, s81, v6
  v_fma_f32 v9, v9, s81, v6
  v_fma_f32 v10, v10, s81, v6
  v_fma_f32 v11, v11, s81, v6
  v_exp_f32 v8, v8
  v_exp_f32 v9, v9
  v_exp_f32 v10, v10
  v_exp_f32 v11, v11
  s_nop 0
  v_cvt_pk_bf16_f32 v42, v8, v9
  v_cvt_pk_bf16_f32 v43, v10, v11
  v_add_f32 v8, v8, v9
  v_add_f32 v10, v10, v11
  v_add_f32 v5, v5, v8
  v_add_f32 v5, v5, v10
  v_lshlrev_b32 v8, 16, v44
  v_and_b32 v9, 0xffff0000, v44
  v_lshlrev_b32 v10, 16, v45
  v_and_b32 v11, 0xffff0000, v45
  v_fma_f32 v8, v8, s81, v6
  v_fma_f32 v9, v9, s81, v6
  v_fma_f32 v10, v10, s81, v6
  v_fma_f32 v11, v11, s81, v6
  v_exp_f32 v8, v8
  v_exp_f32 v9, v9
  v_exp_f32 v10, v10
  v_exp_f32 v11, v11
  s_nop 0
  v_cvt_pk_bf16_f32 v44, v8, v9
  v_cvt_pk_bf16_f32 v45, v10, v11
  v_add_f32 v8, v8, v9
  v_add_f32 v10, v10, v11
  v_add_f32 v5, v5, v8
  v_add_f32 v5, v5, v10
  v_lshlrev_b32 v8, 16, v46
  v_and_b32 v9, 0xffff0000, v46
  v_lshlrev_b32 v10, 16, v47
  v_and_b32 v11, 0xffff0000, v47
  v_fma_f32 v8, v8, s81, v6
  v_fma_f32 v9, v9, s81, v6
  v_fma_f32 v10, v10, s81, v6
  v_fma_f32 v11, v11, s81, v6
  v_exp_f32 v8, v8
  v_exp_f32 v9, v9
  v_exp_f32 v10, v10
  v_exp_f32 v11, v11
  s_nop 0
  v_cvt_pk_bf16_f32 v46, v8, v9
  v_cvt_pk_bf16_f32 v47, v10, v11
  v_add_f32 v8, v8, v9
  v_add_f32 v10, v10, v11
  v_add_f32 v5, v5, v8
  v_add_f32 v5, v5, v10
  v_lshlrev_b32 v8, 16, v48
  v_and_b32 v9, 0xffff0000, v48
  v_lshlrev_b32 v10, 16, v49
  v_and_b32 v11, 0xffff0000, v49
  v_fma_f32 v8, v8, s81, v6
  v_fma_f32 v9, v9, s81, v6
  v_fma_f32 v10, v10, s81, v6
  v_fma_f32 v11, v11, s81, v6
  v_exp_f32 v8, v8
  v_exp_f32 v9, v9
  v_exp_f32 v10, v10
  v_exp_f32 v11, v11
  s_nop 0
  v_cvt_pk_bf16_f32 v48, v8, v9
  v_cvt_pk_bf16_f32 v49, v10, v11
  v_add_f32 v8, v8, v9
  v_add_f32 v10, v10, v11
  v_add_f32 v5, v5, v8
  v_add_f32 v5, v5, v10
  v_lshlrev_b32 v8, 16, v50
  v_and_b32 v9, 0xffff0000, v50
  v_lshlrev_b32 v10, 16, v51
  v_and_b32 v11, 0xffff0000, v51
  v_fma_f32 v8, v8, s81, v6
  v_fma_f32 v9, v9, s81, v6
  v_fma_f32 v10, v10, s81, v6
  v_fma_f32 v11, v11, s81, v6
  v_exp_f32 v8, v8
  v_exp_f32 v9, v9
  v_exp_f32 v10, v10
  v_exp_f32 v11, v11
  s_nop 0
  v_cvt_pk_bf16_f32 v50, v8, v9
  v_cvt_pk_bf16_f32 v51, v10, v11
  v_add_f32 v8, v8, v9
  v_add_f32 v10, v10, v11
  v_add_f32 v5, v5, v8
  v_add_f32 v5, v5, v10
  v_lshlrev_b32 v8, 16, v52
  v_and_b32 v9, 0xffff0000, v52
  v_lshlrev_b32 v10, 16, v53
  v_and_b32 v11, 0xffff0000, v53
  v_fma_f32 v8, v8, s81, v6
  v_fma_f32 v9, v9, s81, v6
  v_fma_f32 v10, v10, s81, v6
  v_fma_f32 v11, v11, s81, v6
  v_exp_f32 v8, v8
  v_exp_f32 v9, v9
  v_exp_f32 v10, v10
  v_exp_f32 v11, v11
  s_nop 0
  v_cvt_pk_bf16_f32 v52, v8, v9
  v_cvt_pk_bf16_f32 v53, v10, v11
  v_add_f32 v8, v8, v9
  v_add_f32 v10, v10, v11
  v_add_f32 v5, v5, v8
  v_add_f32 v5, v5, v10
  v_lshlrev_b32 v8, 16, v54
  v_and_b32 v9, 0xffff0000, v54
  v_lshlrev_b32 v10, 16, v55
  v_and_b32 v11, 0xffff0000, v55
  v_fma_f32 v8, v8, s81, v6
  v_fma_f32 v9, v9, s81, v6
  v_fma_f32 v10, v10, s81, v6
  v_fma_f32 v11, v11, s81, v6
  v_exp_f32 v8, v8
  v_exp_f32 v9, v9
  v_exp_f32 v10, v10
  v_exp_f32 v11, v11
  s_nop 0
  v_cvt_pk_bf16_f32 v54, v8, v9
  v_cvt_pk_bf16_f32 v55, v10, v11
  v_add_f32 v8, v8, v9
  v_add_f32 v10, v10, v11
  v_add_f32 v5, v5, v8
  v_add_f32 v5, v5, v10
  v_lshlrev_b32 v8, 16, v56
  v_and_b32 v9, 0xffff0000, v56
  v_lshlrev_b32 v10, 16, v57
  v_and_b32 v11, 0xffff0000, v57
  v_fma_f32 v8, v8, s81, v6
  v_fma_f32 v9, v9, s81, v6
  v_fma_f32 v10, v10, s81, v6
  v_fma_f32 v11, v11, s81, v6
  v_exp_f32 v8, v8
  v_exp_f32 v9, v9
  v_exp_f32 v10, v10
  v_exp_f32 v11, v11
  s_nop 0
  v_cvt_pk_bf16_f32 v56, v8, v9
  v_cvt_pk_bf16_f32 v57, v10, v11
  v_add_f32 v8, v8, v9
  v_add_f32 v10, v10, v11
  v_add_f32 v5, v5, v8
  v_add_f32 v5, v5, v10
  v_lshlrev_b32 v8, 16, v58
  v_and_b32 v9, 0xffff0000, v58
  v_lshlrev_b32 v10, 16, v59
  v_and_b32 v11, 0xffff0000, v59
  v_fma_f32 v8, v8, s81, v6
  v_fma_f32 v9, v9, s81, v6
  v_fma_f32 v10, v10, s81, v6
  v_fma_f32 v11, v11, s81, v6
  v_exp_f32 v8, v8
  v_exp_f32 v9, v9
  v_exp_f32 v10, v10
  v_exp_f32 v11, v11
  s_nop 0
  v_cvt_pk_bf16_f32 v58, v8, v9
  v_cvt_pk_bf16_f32 v59, v10, v11
  v_add_f32 v8, v8, v9
  v_add_f32 v10, v10, v11
  v_add_f32 v5, v5, v8
  v_add_f32 v5, v5, v10
  v_lshlrev_b32 v8, 16, v60
  v_and_b32 v9, 0xffff0000, v60
  v_lshlrev_b32 v10, 16, v61
  v_and_b32 v11, 0xffff0000, v61
  v_fma_f32 v8, v8, s81, v6
  v_fma_f32 v9, v9, s81, v6
  v_fma_f32 v10, v10, s81, v6
  v_fma_f32 v11, v11, s81, v6
  v_exp_f32 v8, v8
  v_exp_f32 v9, v9
  v_exp_f32 v10, v10
  v_exp_f32 v11, v11
  s_nop 0
  v_cvt_pk_bf16_f32 v60, v8, v9
  v_cvt_pk_bf16_f32 v61, v10, v11
  v_add_f32 v8, v8, v9
  v_add_f32 v10, v10, v11
  v_add_f32 v5, v5, v8
  v_add_f32 v5, v5, v10
  v_lshlrev_b32 v8, 16, v62
  v_and_b32 v9, 0xffff0000, v62
  v_lshlrev_b32 v10, 16, v63
  v_and_b32 v11, 0xffff0000, v63
  v_fma_f32 v8, v8, s81, v6
  v_fma_f32 v9, v9, s81, v6
  v_fma_f32 v10, v10, s81, v6
  v_fma_f32 v11, v11, s81, v6
  v_exp_f32 v8, v8
  v_exp_f32 v9, v9
  v_exp_f32 v10, v10
  v_exp_f32 v11, v11
  s_nop 0
  v_cvt_pk_bf16_f32 v62, v8, v9
  v_cvt_pk_bf16_f32 v63, v10, v11
  v_add_f32 v8, v8, v9
  v_add_f32 v10, v10, v11
  v_add_f32 v5, v5, v8
  v_add_f32 v5, v5, v10
  v_mov_b32 v7, v5
  s_nop 1
  v_permlane16_swap_b32 v5, v7
  v_add_f32 v5, v5, v7
  v_mov_b32 v7, v5
  s_nop 1
  v_permlane32_swap_b32 v5, v7
  v_add_f32 v5, v5, v7
  s_and_b32 s65, s2, 63
  s_lshl_b32 s86, s65, 9
  s_add_u32 s86, s86, 4096
  s_lshl_b32 s65, s62, 3
  s_add_u32 s65, s65, s3
  s_lshl_b32 s65, s65, 4
  s_add_u32 s65, s65, s86
  v_or_b32 v8, s78, v4
  v_and_b32 v9, 0xfffffc00, v5
  v_or_b32 v9, s77, v9
  v_mov_b32 v10, s79
  v_mov_b32 v11, s79
  v_mov_b32 v12, 0
  s_mov_b64 exec, 1
  buffer_store_dwordx4 v[8:11], v12, s[44:47], s65 offen sc1
  s_mov_b64 exec, -1
  v_mov_b32 v216, 0
  v_mov_b32 v217, 0
  v_mov_b32 v218, 0
  v_mov_b32 v219, 0
  v_mov_b32 v220, 0
  v_mov_b32 v221, 0
  v_mov_b32 v222, 0
  v_mov_b32 v223, 0
  v_perm_b32 v8, v32, v32, s70
  v_perm_b32 v9, v32, v32, s71
  v_perm_b32 v10, v33, v33, s70
  v_perm_b32 v11, v33, v33, s71
  v_and_b32 v200, v8, v196
  v_and_b32 v201, v8, v197
  v_and_b32 v202, v8, v198
  v_and_b32 v203, v8, v199
  v_and_b32 v204, v9, v196
  v_and_b32 v205, v9, v197
  v_and_b32 v206, v9, v198
  v_and_b32 v207, v9, v199
  v_and_b32 v208, v10, v196
  v_and_b32 v209, v10, v197
  v_and_b32 v210, v10, v198
  v_and_b32 v211, v10, v199
  v_and_b32 v212, v11, v196
  v_and_b32 v213, v11, v197
  v_and_b32 v214, v11, v198
  v_and_b32 v215, v11, v199
  s_waitcnt vmcnt(16)
  v_mfma_f32_16x16x32_bf16 v[216:219], v[200:203], v[64:67], v[216:219]
  v_mfma_f32_16x16x32_bf16 v[220:223], v[204:207], v[68:71], v[220:223]
  v_mfma_f32_16x16x32_bf16 v[216:219], v[208:211], v[72:75], v[216:219]
  v_mfma_f32_16x16x32_bf16 v[220:223], v[212:215], v[76:79], v[220:223]
  s_add_u32 s65, s64, 65536
  buffer_load_dwordx4 v[64:67], v2, s[28:31], s65 offen offset:0 nt
  buffer_load_dwordx4 v[68:71], v2, s[28:31], s65 offen offset:1024 nt
  buffer_load_dwordx4 v[72:75], v2, s[28:31], s65 offen offset:2048 nt
  buffer_load_dwordx4 v[76:79], v2, s[28:31], s65 offen offset:3072 nt
  s_add_u32 s65, s72, 2048
  buffer_load_dwordx4 v[160:163], v227, s[36:39], s65 offen offset:0
  v_perm_b32 v8, v34, v34, s70
  v_perm_b32 v9, v34, v34, s71
  v_perm_b32 v10, v35, v35, s70
  v_perm_b32 v11, v35, v35, s71
  v_and_b32 v200, v8, v196
  v_and_b32 v201, v8, v197
  v_and_b32 v202, v8, v198
  v_and_b32 v203, v8, v199
  v_and_b32 v204, v9, v196
  v_and_b32 v205, v9, v197
  v_and_b32 v206, v9, v198
  v_and_b32 v207, v9, v199
  v_and_b32 v208, v10, v196
  v_and_b32 v209, v10, v197
  v_and_b32 v210, v10, v198
  v_and_b32 v211, v10, v199
  v_and_b32 v212, v11, v196
  v_and_b32 v213, v11, v197
  v_and_b32 v214, v11, v198
  v_and_b32 v215, v11, v199
  s_waitcnt vmcnt(16)
  v_mfma_f32_16x16x32_bf16 v[216:219], v[200:203], v[80:83], v[216:219]
  v_mfma_f32_16x16x32_bf16 v[220:223], v[204:207], v[84:87], v[220:223]
  v_mfma_f32_16x16x32_bf16 v[216:219], v[208:211], v[88:91], v[216:219]
  v_mfma_f32_16x16x32_bf16 v[220:223], v[212:215], v[92:95], v[220:223]
  s_add_u32 s65, s64, 81920
  buffer_load_dwordx4 v[80:83], v2, s[28:31], s65 offen offset:0 nt
  buffer_load_dwordx4 v[84:87], v2, s[28:31], s65 offen offset:1024 nt
  buffer_load_dwordx4 v[88:91], v2, s[28:31], s65 offen offset:2048 nt
  buffer_load_dwordx4 v[92:95], v2, s[28:31], s65 offen offset:3072 nt
  s_add_u32 s65, s72, 2048
  buffer_load_dwordx4 v[164:167], v227, s[36:39], s65 offen offset:256
  v_perm_b32 v8, v36, v36, s70
  v_perm_b32 v9, v36, v36, s71
  v_perm_b32 v10, v37, v37, s70
  v_perm_b32 v11, v37, v37, s71
  v_and_b32 v200, v8, v196
  v_and_b32 v201, v8, v197
  v_and_b32 v202, v8, v198
  v_and_b32 v203, v8, v199
  v_and_b32 v204, v9, v196
  v_and_b32 v205, v9, v197
  v_and_b32 v206, v9, v198
  v_and_b32 v207, v9, v199
  v_and_b32 v208, v10, v196
  v_and_b32 v209, v10, v197
  v_and_b32 v210, v10, v198
  v_and_b32 v211, v10, v199
  v_and_b32 v212, v11, v196
  v_and_b32 v213, v11, v197
  v_and_b32 v214, v11, v198
  v_and_b32 v215, v11, v199
  s_waitcnt vmcnt(16)
  v_mfma_f32_16x16x32_bf16 v[216:219], v[200:203], v[96:99], v[216:219]
  v_mfma_f32_16x16x32_bf16 v[220:223], v[204:207], v[100:103], v[220:223]
  v_mfma_f32_16x16x32_bf16 v[216:219], v[208:211], v[104:107], v[216:219]
  v_mfma_f32_16x16x32_bf16 v[220:223], v[212:215], v[108:111], v[220:223]
  s_add_u32 s65, s64, 98304
  buffer_load_dwordx4 v[96:99], v2, s[28:31], s65 offen offset:0 nt
  buffer_load_dwordx4 v[100:103], v2, s[28:31], s65 offen offset:1024 nt
  buffer_load_dwordx4 v[104:107], v2, s[28:31], s65 offen offset:2048 nt
  buffer_load_dwordx4 v[108:111], v2, s[28:31], s65 offen offset:3072 nt
  s_add_u32 s65, s72, 2048
  buffer_load_dwordx4 v[168:171], v227, s[36:39], s65 offen offset:512
  v_perm_b32 v8, v38, v38, s70
  v_perm_b32 v9, v38, v38, s71
  v_perm_b32 v10, v39, v39, s70
  v_perm_b32 v11, v39, v39, s71
  v_and_b32 v200, v8, v196
  v_and_b32 v201, v8, v197
  v_and_b32 v202, v8, v198
  v_and_b32 v203, v8, v199
  v_and_b32 v204, v9, v196
  v_and_b32 v205, v9, v197
  v_and_b32 v206, v9, v198
  v_and_b32 v207, v9, v199
  v_and_b32 v208, v10, v196
  v_and_b32 v209, v10, v197
  v_and_b32 v210, v10, v198
  v_and_b32 v211, v10, v199
  v_and_b32 v212, v11, v196
  v_and_b32 v213, v11, v197
  v_and_b32 v214, v11, v198
  v_and_b32 v215, v11, v199
  s_waitcnt vmcnt(16)
  v_mfma_f32_16x16x32_bf16 v[216:219], v[200:203], v[112:115], v[216:219]
  v_mfma_f32_16x16x32_bf16 v[220:223], v[204:207], v[116:119], v[220:223]
  v_mfma_f32_16x16x32_bf16 v[216:219], v[208:211], v[120:123], v[216:219]
  v_mfma_f32_16x16x32_bf16 v[220:223], v[212:215], v[124:127], v[220:223]
  s_add_u32 s65, s64, 114688
  buffer_load_dwordx4 v[112:115], v2, s[28:31], s65 offen offset:0 nt
  buffer_load_dwordx4 v[116:119], v2, s[28:31], s65 offen offset:1024 nt
  buffer_load_dwordx4 v[120:123], v2, s[28:31], s65 offen offset:2048 nt
  buffer_load_dwordx4 v[124:127], v2, s[28:31], s65 offen offset:3072 nt
  s_add_u32 s65, s72, 2048
  buffer_load_dwordx4 v[172:175], v227, s[36:39], s65 offen offset:768
  v_perm_b32 v8, v40, v40, s70
  v_perm_b32 v9, v40, v40, s71
  v_perm_b32 v10, v41, v41, s70
  v_perm_b32 v11, v41, v41, s71
  v_and_b32 v200, v8, v196
  v_and_b32 v201, v8, v197
  v_and_b32 v202, v8, v198
  v_and_b32 v203, v8, v199
  v_and_b32 v204, v9, v196
  v_and_b32 v205, v9, v197
  v_and_b32 v206, v9, v198
  v_and_b32 v207, v9, v199
  v_and_b32 v208, v10, v196
  v_and_b32 v209, v10, v197
  v_and_b32 v210, v10, v198
  v_and_b32 v211, v10, v199
  v_and_b32 v212, v11, v196
  v_and_b32 v213, v11, v197
  v_and_b32 v214, v11, v198
  v_and_b32 v215, v11, v199
  s_waitcnt vmcnt(16)
  v_mfma_f32_16x16x32_bf16 v[216:219], v[200:203], v[64:67], v[216:219]
  v_mfma_f32_16x16x32_bf16 v[220:223], v[204:207], v[68:71], v[220:223]
  v_mfma_f32_16x16x32_bf16 v[216:219], v[208:211], v[72:75], v[216:219]
  v_mfma_f32_16x16x32_bf16 v[220:223], v[212:215], v[76:79], v[220:223]
  s_add_u32 s65, s64, 131072
  buffer_load_dwordx4 v[64:67], v2, s[28:31], s65 offen offset:0 nt
  buffer_load_dwordx4 v[68:71], v2, s[28:31], s65 offen offset:1024 nt
  buffer_load_dwordx4 v[72:75], v2, s[28:31], s65 offen offset:2048 nt
  buffer_load_dwordx4 v[76:79], v2, s[28:31], s65 offen offset:3072 nt
  s_add_u32 s65, s72, 3072
  buffer_load_dwordx4 v[176:179], v227, s[36:39], s65 offen offset:0
  v_perm_b32 v8, v42, v42, s70
  v_perm_b32 v9, v42, v42, s71
  v_perm_b32 v10, v43, v43, s70
  v_perm_b32 v11, v43, v43, s71
  v_and_b32 v200, v8, v196
  v_and_b32 v201, v8, v197
  v_and_b32 v202, v8, v198
  v_and_b32 v203, v8, v199
  v_and_b32 v204, v9, v196
  v_and_b32 v205, v9, v197
  v_and_b32 v206, v9, v198
  v_and_b32 v207, v9, v199
  v_and_b32 v208, v10, v196
  v_and_b32 v209, v10, v197
  v_and_b32 v210, v10, v198
  v_and_b32 v211, v10, v199
  v_and_b32 v212, v11, v196
  v_and_b32 v213, v11, v197
  v_and_b32 v214, v11, v198
  v_and_b32 v215, v11, v199
  s_waitcnt vmcnt(16)
  v_mfma_f32_16x16x32_bf16 v[216:219], v[200:203], v[80:83], v[216:219]
  v_mfma_f32_16x16x32_bf16 v[220:223], v[204:207], v[84:87], v[220:223]
  v_mfma_f32_16x16x32_bf16 v[216:219], v[208:211], v[88:91], v[216:219]
  v_mfma_f32_16x16x32_bf16 v[220:223], v[212:215], v[92:95], v[220:223]
  s_add_u32 s65, s64, 147456
  buffer_load_dwordx4 v[80:83], v2, s[28:31], s65 offen offset:0 nt
  buffer_load_dwordx4 v[84:87], v2, s[28:31], s65 offen offset:1024 nt
  buffer_load_dwordx4 v[88:91], v2, s[28:31], s65 offen offset:2048 nt
  buffer_load_dwordx4 v[92:95], v2, s[28:31], s65 offen offset:3072 nt
  s_add_u32 s65, s72, 3072
  buffer_load_dwordx4 v[180:183], v227, s[36:39], s65 offen offset:256
  v_perm_b32 v8, v44, v44, s70
  v_perm_b32 v9, v44, v44, s71
  v_perm_b32 v10, v45, v45, s70
  v_perm_b32 v11, v45, v45, s71
  v_and_b32 v200, v8, v196
  v_and_b32 v201, v8, v197
  v_and_b32 v202, v8, v198
  v_and_b32 v203, v8, v199
  v_and_b32 v204, v9, v196
  v_and_b32 v205, v9, v197
  v_and_b32 v206, v9, v198
  v_and_b32 v207, v9, v199
  v_and_b32 v208, v10, v196
  v_and_b32 v209, v10, v197
  v_and_b32 v210, v10, v198
  v_and_b32 v211, v10, v199
  v_and_b32 v212, v11, v196
  v_and_b32 v213, v11, v197
  v_and_b32 v214, v11, v198
  v_and_b32 v215, v11, v199
  s_waitcnt vmcnt(16)
  v_mfma_f32_16x16x32_bf16 v[216:219], v[200:203], v[96:99], v[216:219]
  v_mfma_f32_16x16x32_bf16 v[220:223], v[204:207], v[100:103], v[220:223]
  v_mfma_f32_16x16x32_bf16 v[216:219], v[208:211], v[104:107], v[216:219]
  v_mfma_f32_16x16x32_bf16 v[220:223], v[212:215], v[108:111], v[220:223]
  s_add_u32 s65, s64, 163840
  buffer_load_dwordx4 v[96:99], v2, s[28:31], s65 offen offset:0 nt
  buffer_load_dwordx4 v[100:103], v2, s[28:31], s65 offen offset:1024 nt
  buffer_load_dwordx4 v[104:107], v2, s[28:31], s65 offen offset:2048 nt
  buffer_load_dwordx4 v[108:111], v2, s[28:31], s65 offen offset:3072 nt
  s_add_u32 s65, s72, 3072
  buffer_load_dwordx4 v[184:187], v227, s[36:39], s65 offen offset:512
  v_perm_b32 v8, v46, v46, s70
  v_perm_b32 v9, v46, v46, s71
  v_perm_b32 v10, v47, v47, s70
  v_perm_b32 v11, v47, v47, s71
  v_and_b32 v200, v8, v196
  v_and_b32 v201, v8, v197
  v_and_b32 v202, v8, v198
  v_and_b32 v203, v8, v199
  v_and_b32 v204, v9, v196
  v_and_b32 v205, v9, v197
  v_and_b32 v206, v9, v198
  v_and_b32 v207, v9, v199
  v_and_b32 v208, v10, v196
  v_and_b32 v209, v10, v197
  v_and_b32 v210, v10, v198
  v_and_b32 v211, v10, v199
  v_and_b32 v212, v11, v196
  v_and_b32 v213, v11, v197
  v_and_b32 v214, v11, v198
  v_and_b32 v215, v11, v199
  s_waitcnt vmcnt(16)
  v_mfma_f32_16x16x32_bf16 v[216:219], v[200:203], v[112:115], v[216:219]
  v_mfma_f32_16x16x32_bf16 v[220:223], v[204:207], v[116:119], v[220:223]
  v_mfma_f32_16x16x32_bf16 v[216:219], v[208:211], v[120:123], v[216:219]
  v_mfma_f32_16x16x32_bf16 v[220:223], v[212:215], v[124:127], v[220:223]
  s_add_u32 s65, s64, 180224
  buffer_load_dwordx4 v[112:115], v2, s[28:31], s65 offen offset:0 nt
  buffer_load_dwordx4 v[116:119], v2, s[28:31], s65 offen offset:1024 nt
  buffer_load_dwordx4 v[120:123], v2, s[28:31], s65 offen offset:2048 nt
  buffer_load_dwordx4 v[124:127], v2, s[28:31], s65 offen offset:3072 nt
  s_add_u32 s65, s72, 3072
  buffer_load_dwordx4 v[188:191], v227, s[36:39], s65 offen offset:768
  v_perm_b32 v8, v48, v48, s70
  v_perm_b32 v9, v48, v48, s71
  v_perm_b32 v10, v49, v49, s70
  v_perm_b32 v11, v49, v49, s71
  v_and_b32 v200, v8, v196
  v_and_b32 v201, v8, v197
  v_and_b32 v202, v8, v198
  v_and_b32 v203, v8, v199
  v_and_b32 v204, v9, v196
  v_and_b32 v205, v9, v197
  v_and_b32 v206, v9, v198
  v_and_b32 v207, v9, v199
  v_and_b32 v208, v10, v196
  v_and_b32 v209, v10, v197
  v_and_b32 v210, v10, v198
  v_and_b32 v211, v10, v199
  v_and_b32 v212, v11, v196
  v_and_b32 v213, v11, v197
  v_and_b32 v214, v11, v198
  v_and_b32 v215, v11, v199
  s_waitcnt vmcnt(16)
  v_mfma_f32_16x16x32_bf16 v[216:219], v[200:203], v[64:67], v[216:219]
  v_mfma_f32_16x16x32_bf16 v[220:223], v[204:207], v[68:71], v[220:223]
  v_mfma_f32_16x16x32_bf16 v[216:219], v[208:211], v[72:75], v[216:219]
  v_mfma_f32_16x16x32_bf16 v[220:223], v[212:215], v[76:79], v[220:223]
  s_add_u32 s65, s64, 196608
  buffer_load_dwordx4 v[64:67], v2, s[28:31], s65 offen offset:0 nt
  buffer_load_dwordx4 v[68:71], v2, s[28:31], s65 offen offset:1024 nt
  buffer_load_dwordx4 v[72:75], v2, s[28:31], s65 offen offset:2048 nt
  buffer_load_dwordx4 v[76:79], v2, s[28:31], s65 offen offset:3072 nt
  v_perm_b32 v8, v50, v50, s70
  v_perm_b32 v9, v50, v50, s71
  v_perm_b32 v10, v51, v51, s70
  v_perm_b32 v11, v51, v51, s71
  v_and_b32 v200, v8, v196
  v_and_b32 v201, v8, v197
  v_and_b32 v202, v8, v198
  v_and_b32 v203, v8, v199
  v_and_b32 v204, v9, v196
  v_and_b32 v205, v9, v197
  v_and_b32 v206, v9, v198
  v_and_b32 v207, v9, v199
  v_and_b32 v208, v10, v196
  v_and_b32 v209, v10, v197
  v_and_b32 v210, v10, v198
  v_and_b32 v211, v10, v199
  v_and_b32 v212, v11, v196
  v_and_b32 v213, v11, v197
  v_and_b32 v214, v11, v198
  v_and_b32 v215, v11, v199
  s_waitcnt vmcnt(15)
  v_mfma_f32_16x16x32_bf16 v[216:219], v[200:203], v[80:83], v[216:219]
  v_mfma_f32_16x16x32_bf16 v[220:223], v[204:207], v[84:87], v[220:223]
  v_mfma_f32_16x16x32_bf16 v[216:219], v[208:211], v[88:91], v[216:219]
  v_mfma_f32_16x16x32_bf16 v[220:223], v[212:215], v[92:95], v[220:223]
  s_add_u32 s65, s64, 212992
  buffer_load_dwordx4 v[80:83], v2, s[28:31], s65 offen offset:0 nt
  buffer_load_dwordx4 v[84:87], v2, s[28:31], s65 offen offset:1024 nt
  buffer_load_dwordx4 v[88:91], v2, s[28:31], s65 offen offset:2048 nt
  buffer_load_dwordx4 v[92:95], v2, s[28:31], s65 offen offset:3072 nt
  v_lshlrev_b32 v32, 4, v225
  s_lshl_b32 s65, s3, 6
  v_add_u32 v32, s65, v32
  v_lshlrev_b32 v33, 4, v1
  s_lshl_b32 s65, s3, 11
  s_add_u32 s65, s65, 4096
  v_add_u32 v33, s65, v33
  v_lshlrev_b32 v34, 4, v0
  v_and_b32 v20, 15, v0
  v_lshlrev_b32 v20, 1, v20
  v_bfe_u32 v21, v0, 4, 1
  v_or_b32 v20, v20, v21
  v_and_b32 v21, 0xe0, v0
  v_or_b32 v20, v20, v21
  v_lshlrev_b32 v236, 4, v20
  s_lshl_b32 s7, s2, 11
  s_add_u32 s7, s7, 65536
  s_mov_b32 s40, s4
  s_and_b32 s41, s5, 0xffff
  s_mov_b32 s42, 2048
  s_mov_b32 s43, 0x20000
  s_mov_b32 s32, s22
  s_and_b32 s33, s23, 0xffff
  s_mov_b32 s34, 2048
  s_mov_b32 s35, 0x20000
  s_cmp_eq_u32 s85, 1
  s_cbranch_scc1 suf_sequen_11
  s_cmp_eq_u32 s85, 0
  s_cbranch_scc1 sud_sequen_12
  s_lshr_b32 s67, s87, 4
  s_and_b32 s68, s87, 15
  v_lshrrev_b32 v20, 3, v1
  v_and_b32 v21, 7, v1
  v_lshlrev_b32 v35, 11, v20
  v_lshl_add_u32 v35, v21, 4, v35
  v_lshlrev_b32 v36, 12, v20
  v_lshl_add_u32 v36, v21, 4, v36
  v_cmp_gt_u32 vcc, 6, v20
  v_add_u32 v37, 32768, v36
  s_nop 0
  v_cndmask_b32 v37, v36, v37, vcc
  v_lshrrev_b32 v22, 1, v225
  v_and_b32 v23, 1, v225
  v_lshl_add_u32 v22, v23, 1, v22
  v_lshlrev_b32 v22, 2, v22
  v_lshl_add_u32 v38, v21, 4, v22
  s_lshl_b32 s65, s3, 7
  v_add_u32 v38, s65, v38
  v_and_b32 v22, 31, v1
  v_lshlrev_b32 v39, 2, v22
  v_mov_b32 v41, v39
  s_lshl_b32 s65, s68, 5
  v_add_u32 v24, s65, v22
  v_lshlrev_b32 v24, 1, v24
  s_lshl_b32 s65, s67, 10
  v_add_u32 v40, s65, v24
  buffer_load_ushort v42, v40, s[40:43], 0 offen
  s_lshr_b32 s65, s3, 1
  s_lshl_b32 s65, s65, 6
  s_lshl_b32 s69, s67, 5
  s_add_u32 s65, s65, s69
  s_and_b32 s69, s3, 1
  s_lshl_b32 s69, s69, 4
  s_add_u32 s65, s65, s69
  s_lshl_b32 s65, s65, 11
  s_lshl_b32 s69, s68, 7
  s_add_u32 s65, s65, s69
  s_add_u32 s12, s65, 65536
  s_add_u32 s13, s12, 16384
  s_mul_i32 s65, s3, 57344
  s_lshl_b32 s16, s67, 11
  s_add_u32 s65, s65, s16
  s_add_u32 s65, s65, s69
  s_add_u32 s17, s65, 589824
  s_add_u32 s16, s16, s69
  s_add_u32 s16, s16, 40960
  s_branch sud_sequen_12
suf_sequen_11:
  v_lshrrev_b32 v20, 2, v226
  v_and_b32 v21, 3, v226
  v_lshl_add_u32 v20, v225, 3, v20
  v_lshlrev_b32 v20, 5, v20
  v_lshl_add_u32 v20, v21, 3, v20
  s_lshl_b32 s65, s3, 12
  s_add_u32 s65, s65, 20480
  v_add_u32 v35, s65, v20
  v_lshlrev_b32 v20, 10, v225
  v_lshl_add_u32 v20, v226, 4, v20
  s_lshr_b32 s65, s3, 2
  s_lshl_b32 s65, s65, 13
  s_and_b32 s69, s3, 3
  s_lshl_b32 s69, s69, 8
  s_add_u32 s65, s65, s69
  s_add_u32 s65, s65, 53248
  v_add_u32 v36, s65, v20
  v_lshlrev_b32 v20, 3, v1
  s_lshl_b32 s65, s3, 10
  s_add_u32 s65, s65, 69632
  v_add_u32 v37, s65, v20
  v_and_b32 v20, 1, v1
  v_lshlrev_b32 v20, 10, v20
  v_lshl_add_u32 v20, v225, 4, v20
  s_lshl_b32 s65, s3, 7
  s_add_u32 s65, s65, 69632
  v_add_u32 v38, s65, v20
  s_mov_b32 s65, 144
  v_mul_lo_u32 v20, v1, s65
  s_lshl_b32 s65, s3, 3
  s_add_u32 s65, s65, 71680
  v_add_u32 v39, s65, v20
  s_lshr_b32 s65, s3, 2
  s_lshl_b32 s65, s65, 3
  v_add_u32 v20, s65, v225
  s_mov_b32 s65, 144
  v_mul_lo_u32 v20, v20, s65
  v_lshrrev_b32 v21, 3, v226
  v_lshl_add_u32 v20, v21, 6, v20
  v_add_u32 v40, 71680, v20
  v_lshlrev_b32 v20, 4, v1
  s_lshl_b32 s65, s3, 10
  s_add_u32 s65, s65, 4096
  v_add_u32 v41, s65, v20
  v_lshrrev_b32 v20, 7, v0
  v_and_b32 v21, 127, v0
  v_lshrrev_b32 v22, 5, v21
  v_and_b32 v21, 31, v21
  v_lshl_add_u32 v21, v20, 5, v21
  v_lshlrev_b32 v21, 4, v21
  v_lshl_add_u32 v21, v22, 10, v21
  v_add_u32 v42, 4096, v21
  s_lshl_b32 s12, s3, 11
  s_add_u32 s12, s12, 40960
  s_add_u32 s13, s12, 1024
  s_lshl_b32 s16, s87, 12
  s_add_u32 s16, s16, 589824
sud_sequen_12:
  s_barrier
  v_and_b32 v229, 31, v1
  v_lshlrev_b32 v229, 4, v229
  buffer_load_dwordx4 v[230:233], v229, s[44:47], s86 offen sc1
  v_perm_b32 v8, v52, v52, s70
  v_perm_b32 v9, v52, v52, s71
  v_perm_b32 v10, v53, v53, s70
  v_perm_b32 v11, v53, v53, s71
  v_and_b32 v200, v8, v196
  v_and_b32 v201, v8, v197
  v_and_b32 v202, v8, v198
  v_and_b32 v203, v8, v199
  v_and_b32 v204, v9, v196
  v_and_b32 v205, v9, v197
  v_and_b32 v206, v9, v198
  v_and_b32 v207, v9, v199
  v_and_b32 v208, v10, v196
  v_and_b32 v209, v10, v197
  v_and_b32 v210, v10, v198
  v_and_b32 v211, v10, v199
  v_and_b32 v212, v11, v196
  v_and_b32 v213, v11, v197
  v_and_b32 v214, v11, v198
  v_and_b32 v215, v11, v199
  s_waitcnt vmcnt(15)
  v_mfma_f32_16x16x32_bf16 v[216:219], v[200:203], v[96:99], v[216:219]
  v_mfma_f32_16x16x32_bf16 v[220:223], v[204:207], v[100:103], v[220:223]
  v_mfma_f32_16x16x32_bf16 v[216:219], v[208:211], v[104:107], v[216:219]
  v_mfma_f32_16x16x32_bf16 v[220:223], v[212:215], v[108:111], v[220:223]
  s_add_u32 s65, s64, 229376
  buffer_load_dwordx4 v[96:99], v2, s[28:31], s65 offen offset:0 nt
  buffer_load_dwordx4 v[100:103], v2, s[28:31], s65 offen offset:1024 nt
  buffer_load_dwordx4 v[104:107], v2, s[28:31], s65 offen offset:2048 nt
  buffer_load_dwordx4 v[108:111], v2, s[28:31], s65 offen offset:3072 nt
  v_perm_b32 v8, v54, v54, s70
  v_perm_b32 v9, v54, v54, s71
  v_perm_b32 v10, v55, v55, s70
  v_perm_b32 v11, v55, v55, s71
  v_and_b32 v200, v8, v196
  v_and_b32 v201, v8, v197
  v_and_b32 v202, v8, v198
  v_and_b32 v203, v8, v199
  v_and_b32 v204, v9, v196
  v_and_b32 v205, v9, v197
  v_and_b32 v206, v9, v198
  v_and_b32 v207, v9, v199
  v_and_b32 v208, v10, v196
  v_and_b32 v209, v10, v197
  v_and_b32 v210, v10, v198
  v_and_b32 v211, v10, v199
  v_and_b32 v212, v11, v196
  v_and_b32 v213, v11, v197
  v_and_b32 v214, v11, v198
  v_and_b32 v215, v11, v199
  s_waitcnt vmcnt(14)
  v_mfma_f32_16x16x32_bf16 v[216:219], v[200:203], v[112:115], v[216:219]
  v_mfma_f32_16x16x32_bf16 v[220:223], v[204:207], v[116:119], v[220:223]
  v_mfma_f32_16x16x32_bf16 v[216:219], v[208:211], v[120:123], v[216:219]
  v_mfma_f32_16x16x32_bf16 v[220:223], v[212:215], v[124:127], v[220:223]
  s_add_u32 s65, s64, 245760
  buffer_load_dwordx4 v[112:115], v2, s[28:31], s65 offen offset:0 nt
  buffer_load_dwordx4 v[116:119], v2, s[28:31], s65 offen offset:1024 nt
  buffer_load_dwordx4 v[120:123], v2, s[28:31], s65 offen offset:2048 nt
  buffer_load_dwordx4 v[124:127], v2, s[28:31], s65 offen offset:3072 nt
  v_perm_b32 v8, v56, v56, s70
  v_perm_b32 v9, v56, v56, s71
  v_perm_b32 v10, v57, v57, s70
  v_perm_b32 v11, v57, v57, s71
  v_and_b32 v200, v8, v196
  v_and_b32 v201, v8, v197
  v_and_b32 v202, v8, v198
  v_and_b32 v203, v8, v199
  v_and_b32 v204, v9, v196
  v_and_b32 v205, v9, v197
  v_and_b32 v206, v9, v198
  v_and_b32 v207, v9, v199
  v_and_b32 v208, v10, v196
  v_and_b32 v209, v10, v197
  v_and_b32 v210, v10, v198
  v_and_b32 v211, v10, v199
  v_and_b32 v212, v11, v196
  v_and_b32 v213, v11, v197
  v_and_b32 v214, v11, v198
  v_and_b32 v215, v11, v199
  s_waitcnt vmcnt(13)
  v_mfma_f32_16x16x32_bf16 v[216:219], v[200:203], v[64:67], v[216:219]
  v_mfma_f32_16x16x32_bf16 v[220:223], v[204:207], v[68:71], v[220:223]
  v_mfma_f32_16x16x32_bf16 v[216:219], v[208:211], v[72:75], v[216:219]
  v_mfma_f32_16x16x32_bf16 v[220:223], v[212:215], v[76:79], v[220:223]
  v_perm_b32 v8, v58, v58, s70
  v_perm_b32 v9, v58, v58, s71
  v_perm_b32 v10, v59, v59, s70
  v_perm_b32 v11, v59, v59, s71
  v_and_b32 v200, v8, v196
  v_and_b32 v201, v8, v197
  v_and_b32 v202, v8, v198
  v_and_b32 v203, v8, v199
  v_and_b32 v204, v9, v196
  v_and_b32 v205, v9, v197
  v_and_b32 v206, v9, v198
  v_and_b32 v207, v9, v199
  v_and_b32 v208, v10, v196
  v_and_b32 v209, v10, v197
  v_and_b32 v210, v10, v198
  v_and_b32 v211, v10, v199
  v_and_b32 v212, v11, v196
  v_and_b32 v213, v11, v197
  v_and_b32 v214, v11, v198
  v_and_b32 v215, v11, v199
  s_waitcnt vmcnt(9)
  v_mfma_f32_16x16x32_bf16 v[216:219], v[200:203], v[80:83], v[216:219]
  v_mfma_f32_16x16x32_bf16 v[220:223], v[204:207], v[84:87], v[220:223]
  v_mfma_f32_16x16x32_bf16 v[216:219], v[208:211], v[88:91], v[216:219]
  v_mfma_f32_16x16x32_bf16 v[220:223], v[212:215], v[92:95], v[220:223]
  s_waitcnt vmcnt(8)
  v_and_b32 v12, 0xffff, v230
  v_and_b32 v13, 0x3ff, v231
  v_cmp_ne_u32 s[68:69], s78, v12
  v_cmp_ne_u32 vcc, s77, v13
  s_or_b64 s[68:69], s[68:69], vcc
  v_cmp_ne_u32 vcc, s79, v232
  s_or_b64 s[68:69], s[68:69], vcc
  v_cmp_ne_u32 vcc, s79, v233
  s_or_b64 s[68:69], s[68:69], vcc
  s_cmp_eq_u64 s[68:69], 0
  s_cbranch_scc1 mlok_sequen_13
  s_mov_b32 s84, 20000
mlp_sequen_14:
  buffer_load_dwordx4 v[230:233], v229, s[44:47], s86 offen sc1
  s_waitcnt vmcnt(0)
  v_and_b32 v12, 0xffff, v230
  v_and_b32 v13, 0x3ff, v231
  v_cmp_ne_u32 s[68:69], s78, v12
  v_cmp_ne_u32 vcc, s77, v13
  s_or_b64 s[68:69], s[68:69], vcc
  v_cmp_ne_u32 vcc, s79, v232
  s_or_b64 s[68:69], s[68:69], vcc
  v_cmp_ne_u32 vcc, s79, v233
  s_or_b64 s[68:69], s[68:69], vcc
  s_cmp_eq_u64 s[68:69], 0
  s_cbranch_scc1 mlok_sequen_13
  s_sub_u32 s84, s84, 1
  s_cbranch_scc0 mlp_sequen_14
mlok_sequen_13:
  v_and_b32 v12, 0xffff0000, v230
  v_and_b32 v13, 0xfffffc00, v231
  v_mov_b32 v14, v12
  s_nop 1
  v_max_f32_dpp v14, v14, v14 row_ror:8 row_mask:0xf bank_mask:0xf
  s_nop 1
  v_max_f32_dpp v14, v14, v14 row_ror:4 row_mask:0xf bank_mask:0xf
  s_nop 1
  v_max_f32_dpp v14, v14, v14 row_ror:2 row_mask:0xf bank_mask:0xf
  s_nop 1
  v_max_f32_dpp v14, v14, v14 row_ror:1 row_mask:0xf bank_mask:0xf
  v_mov_b32 v7, v14
  s_nop 1
  v_permlane16_swap_b32 v14, v7
  v_max_f32 v14, v14, v7
  v_mov_b32 v7, v14
  s_nop 1
  v_permlane32_swap_b32 v14, v7
  v_max_f32 v14, v14, v7
  v_sub_f32 v12, v12, v14
  v_mul_f32 v12, s81, v12
  v_exp_f32 v12, v12
  s_nop 0
  v_mul_f32 v13, v13, v12
  s_nop 1
  v_add_f32_dpp v13, v13, v13 row_ror:8 row_mask:0xf bank_mask:0xf
  s_nop 1
  v_add_f32_dpp v13, v13, v13 row_ror:4 row_mask:0xf bank_mask:0xf
  s_nop 1
  v_add_f32_dpp v13, v13, v13 row_ror:2 row_mask:0xf bank_mask:0xf
  s_nop 1
  v_add_f32_dpp v13, v13, v13 row_ror:1 row_mask:0xf bank_mask:0xf
  v_mov_b32 v7, v13
  s_nop 1
  v_permlane16_swap_b32 v13, v7
  v_add_f32 v13, v13, v7
  v_sub_f32 v12, v4, v14
  v_mul_f32 v12, s81, v12
  v_exp_f32 v12, v12
  v_rcp_f32 v15, v13
  s_nop 0
  v_mul_f32 v14, v12, v15
  v_fma_f32 v12, -v14, v13, v12
  v_fma_f32 v234, v12, v15, v14
  v_mov_b32 v235, 0xfffffc00
  v_perm_b32 v8, v60, v60, s70
  v_perm_b32 v9, v60, v60, s71
  v_perm_b32 v10, v61, v61, s70
  v_perm_b32 v11, v61, v61, s71
  v_and_b32 v200, v8, v196
  v_and_b32 v201, v8, v197
  v_and_b32 v202, v8, v198
  v_and_b32 v203, v8, v199
  v_and_b32 v204, v9, v196
  v_and_b32 v205, v9, v197
  v_and_b32 v206, v9, v198
  v_and_b32 v207, v9, v199
  v_and_b32 v208, v10, v196
  v_and_b32 v209, v10, v197
  v_and_b32 v210, v10, v198
  v_and_b32 v211, v10, v199
  v_and_b32 v212, v11, v196
  v_and_b32 v213, v11, v197
  v_and_b32 v214, v11, v198
  v_and_b32 v215, v11, v199
  s_waitcnt vmcnt(4)
  v_mfma_f32_16x16x32_bf16 v[216:219], v[200:203], v[96:99], v[216:219]
  v_mfma_f32_16x16x32_bf16 v[220:223], v[204:207], v[100:103], v[220:223]
  v_mfma_f32_16x16x32_bf16 v[216:219], v[208:211], v[104:107], v[216:219]
  v_mfma_f32_16x16x32_bf16 v[220:223], v[212:215], v[108:111], v[220:223]
  v_perm_b32 v8, v62, v62, s70
  v_perm_b32 v9, v62, v62, s71
  v_perm_b32 v10, v63, v63, s70
  v_perm_b32 v11, v63, v63, s71
  v_and_b32 v200, v8, v196
  v_and_b32 v201, v8, v197
  v_and_b32 v202, v8, v198
  v_and_b32 v203, v8, v199
  v_and_b32 v204, v9, v196
  v_and_b32 v205, v9, v197
  v_and_b32 v206, v9, v198
  v_and_b32 v207, v9, v199
  v_and_b32 v208, v10, v196
  v_and_b32 v209, v10, v197
  v_and_b32 v210, v10, v198
  v_and_b32 v211, v10, v199
  v_and_b32 v212, v11, v196
  v_and_b32 v213, v11, v197
  v_and_b32 v214, v11, v198
  v_and_b32 v215, v11, v199
  s_waitcnt vmcnt(0)
  v_mfma_f32_16x16x32_bf16 v[216:219], v[200:203], v[112:115], v[216:219]
  v_mfma_f32_16x16x32_bf16 v[220:223], v[204:207], v[116:119], v[220:223]
  v_mfma_f32_16x16x32_bf16 v[216:219], v[208:211], v[120:123], v[216:219]
  v_mfma_f32_16x16x32_bf16 v[220:223], v[212:215], v[124:127], v[220:223]
  v_cmp_gt_u32 vcc, 32, v1
  s_nop 6
  v_add_f32 v216, v216, v220
  v_add_f32 v217, v217, v221
  v_add_f32 v218, v218, v222
  v_add_f32 v219, v219, v223
  v_mul_f32 v216, v216, v234
  v_mul_f32 v217, v217, v234
  v_mul_f32 v218, v218, v234
  v_mul_f32 v219, v219, v234
  s_and_saveexec_b64 s[82:83], vcc
  ds_write_b128 v224, v[216:219]
  s_mov_b64 exec, s[82:83]
  s_waitcnt vmcnt(0)
  s_waitcnt lgkmcnt(0)
  s_barrier
  ds_read_b128 v[64:67], v32 offset:0
  ds_read_b128 v[68:71], v32 offset:512
  ds_read_b128 v[72:75], v32 offset:1024
  ds_read_b128 v[76:79], v32 offset:1536
  ds_read_b128 v[80:83], v32 offset:2048
  ds_read_b128 v[84:87], v32 offset:2560
  ds_read_b128 v[88:91], v32 offset:3072
  ds_read_b128 v[92:95], v32 offset:3584
  s_waitcnt lgkmcnt(4)
  v_add_f32 v64, v64, v68
  v_add_f32 v72, v72, v76
  v_add_f32 v65, v65, v69
  v_add_f32 v73, v73, v77
  v_add_f32 v66, v66, v70
  v_add_f32 v74, v74, v78
  v_add_f32 v67, v67, v71
  v_add_f32 v75, v75, v79
  s_waitcnt lgkmcnt(0)
  v_add_f32 v80, v80, v84
  v_add_f32 v88, v88, v92
  v_add_f32 v81, v81, v85
  v_add_f32 v89, v89, v93
  v_add_f32 v82, v82, v86
  v_add_f32 v90, v90, v94
  v_add_f32 v83, v83, v87
  v_add_f32 v91, v91, v95
  v_add_f32 v64, v64, v72
  v_add_f32 v80, v80, v88
  v_add_f32 v65, v65, v73
  v_add_f32 v81, v81, v89
  v_add_f32 v66, v66, v74
  v_add_f32 v82, v82, v90
  v_add_f32 v67, v67, v75
  v_add_f32 v83, v83, v91
  v_add_f32 v64, v64, v80
  v_add_f32 v65, v65, v81
  v_add_f32 v66, v66, v82
  v_add_f32 v67, v67, v83
  v_cvt_pk_bf16_f32 v8, v64, v64
  v_cvt_pk_bf16_f32 v9, v65, v65
  v_cvt_pk_bf16_f32 v10, v66, v66
  v_cvt_pk_bf16_f32 v11, v67, v67
  v_and_b32 v200, v8, v196
  v_and_b32 v201, v8, v197
  v_and_b32 v202, v8, v198
  v_and_b32 v203, v8, v199
  v_and_b32 v204, v9, v196
  v_and_b32 v205, v9, v197
  v_and_b32 v206, v9, v198
  v_and_b32 v207, v9, v199
  v_and_b32 v208, v10, v196
  v_and_b32 v209, v10, v197
  v_and_b32 v210, v10, v198
  v_and_b32 v211, v10, v199
  v_and_b32 v212, v11, v196
  v_and_b32 v213, v11, v197
  v_and_b32 v214, v11, v198
  v_and_b32 v215, v11, v199
  v_mfma_f32_16x16x32_bf16 v[96:99], v[200:203], v[128:131], 0
  v_mfma_f32_16x16x32_bf16 v[100:103], v[200:203], v[132:135], 0
  v_mfma_f32_16x16x32_bf16 v[104:107], v[200:203], v[136:139], 0
  v_mfma_f32_16x16x32_bf16 v[108:111], v[200:203], v[140:143], 0
  v_mfma_f32_16x16x32_bf16 v[96:99], v[204:207], v[144:147], v[96:99]
  v_mfma_f32_16x16x32_bf16 v[100:103], v[204:207], v[148:151], v[100:103]
  v_mfma_f32_16x16x32_bf16 v[104:107], v[204:207], v[152:155], v[104:107]
  v_mfma_f32_16x16x32_bf16 v[108:111], v[204:207], v[156:159], v[108:111]
  v_mfma_f32_16x16x32_bf16 v[96:99], v[208:211], v[160:163], v[96:99]
  v_mfma_f32_16x16x32_bf16 v[100:103], v[208:211], v[164:167], v[100:103]
  v_mfma_f32_16x16x32_bf16 v[104:107], v[208:211], v[168:171], v[104:107]
  v_mfma_f32_16x16x32_bf16 v[108:111], v[208:211], v[172:175], v[108:111]
  v_mfma_f32_16x16x32_bf16 v[96:99], v[212:215], v[176:179], v[96:99]
  v_mfma_f32_16x16x32_bf16 v[100:103], v[212:215], v[180:183], v[100:103]
  v_mfma_f32_16x16x32_bf16 v[104:107], v[212:215], v[184:187], v[104:107]
  v_mfma_f32_16x16x32_bf16 v[108:111], v[212:215], v[188:191], v[108:111]
  v_cmp_gt_u32 vcc, 32, v1
  s_nop 2
  s_and_saveexec_b64 s[82:83], vcc
  ds_write_b128 v33, v[96:99]
  s_nop 0
  ds_write_b128 v33, v[100:103] offset:512
  s_nop 0
  ds_write_b128 v33, v[104:107] offset:1024
  s_nop 0
  ds_write_b128 v33, v[108:111] offset:1536
  s_mov_b64 exec, s[82:83]
  s_waitcnt lgkmcnt(0)
  s_barrier
  s_cmp_ge_u32 s3, 2
  s_cbranch_scc1 pub_sequen_15
  ds_read_b128 v[64:67], v34 offset:4096
  ds_read_b128 v[68:71], v34 offset:6144
  ds_read_b128 v[72:75], v34 offset:8192
  ds_read_b128 v[76:79], v34 offset:10240
  ds_read_b128 v[80:83], v34 offset:12288
  ds_read_b128 v[84:87], v34 offset:14336
  ds_read_b128 v[88:91], v34 offset:16384
  ds_read_b128 v[92:95], v34 offset:18432
  s_waitcnt lgkmcnt(4)
  v_add_f32 v64, v64, v68
  v_add_f32 v72, v72, v76
  v_add_f32 v65, v65, v69
  v_add_f32 v73, v73, v77
  v_add_f32 v66, v66, v70
  v_add_f32 v74, v74, v78
  v_add_f32 v67, v67, v71
  v_add_f32 v75, v75, v79
  s_waitcnt lgkmcnt(0)
  v_add_f32 v80, v80, v84
  v_add_f32 v88, v88, v92
  v_add_f32 v81, v81, v85
  v_add_f32 v89, v89, v93
  v_add_f32 v82, v82, v86
  v_add_f32 v90, v90, v94
  v_add_f32 v83, v83, v87
  v_add_f32 v91, v91, v95
  v_add_f32 v64, v64, v72
  v_add_f32 v80, v80, v88
  v_add_f32 v65, v65, v73
  v_add_f32 v81, v81, v89
  v_add_f32 v66, v66, v74
  v_add_f32 v82, v82, v90
  v_add_f32 v67, v67, v75
  v_add_f32 v83, v83, v91
  v_add_f32 v64, v64, v80
  v_add_f32 v65, v65, v81
  v_add_f32 v66, v66, v82
  v_add_f32 v67, v67, v83
  v_and_or_b32 v64, v64, v235, s77
  v_and_or_b32 v65, v65, v235, s77
  v_and_or_b32 v66, v66, v235, s77
  v_and_or_b32 v67, v67, v235, s77
  buffer_store_dwordx4 v[64:67], v236, s[44:47], s7 offen sc1
pub_sequen_15:
  s_cmp_eq_u32 s85, 2
  s_cbranch_scc1 red_sequen_8
  s_cmp_eq_u32 s85, 1
  s_cbranch_scc1 ffn_sequen_9
  s_branch fin_sequen_10
red_sequen_8:
  s_mov_b32 s84, 20000
  s_mov_b64 s[82:83], exec
poll_sequen_16:
  buffer_load_dwordx4 v[64:67], v35, s[44:47], s12 offen sc1
  buffer_load_dwordx4 v[68:71], v35, s[44:47], s13 offen sc1
  s_waitcnt vmcnt(0)
  v_bitop3_b32 v12, v64, v65, v66 bitop3:0x80
  v_or3_b32 v13, v64, v65, v66
  v_bitop3_b32 v12, v12, v67, v68 bitop3:0x80
  v_or3_b32 v13, v13, v67, v68
  v_bitop3_b32 v12, v12, v69, v70 bitop3:0x80
  v_or3_b32 v13, v13, v69, v70
  v_and_b32 v12, v12, v71
  v_or_b32 v13, v13, v71
  v_xor_b32 v12, s77, v12
  v_xor_b32 v13, s77, v13
  v_or_b32 v12, v12, v13
  v_and_b32 v12, 1023, v12
  v_cmp_ne_u32 vcc, 0, v12
  s_and_b64 exec, exec, vcc
  s_cbranch_execz pdn_sequen_17
  s_sub_u32 s84, s84, 1
  s_cbranch_scc0 poll_sequen_16
pdn_sequen_17:
  s_mov_b64 exec, s[82:83]
  v_and_b32 v20, v235, v64
  v_and_b32 v28, v235, v68
  v_and_b32 v21, v235, v65
  v_and_b32 v29, v235, v69
  v_and_b32 v22, v235, v66
  v_and_b32 v30, v235, v70
  v_and_b32 v23, v235, v67
  v_and_b32 v31, v235, v71
  v_add_f32 v20, v20, v28
  v_add_f32 v21, v21, v29
  v_add_f32 v22, v22, v30
  v_add_f32 v23, v23, v31
  s_nop 0
  v_permlane32_swap_b32 v20, v21
  v_permlane32_swap_b32 v22, v23
  v_add_f32 v20, v20, v21
  v_add_f32 v22, v22, v23
  s_nop 1
  v_permlane16_swap_b32 v20, v22
  v_add_f32 v20, v20, v22
  s_nop 1
  v_add_f32_dpp v20, v20, v20 row_ror:8 row_mask:0xf bank_mask:0xf
  ds_write_b32 v38, v20 offset:0
  s_waitcnt lgkmcnt(0)
  s_barrier
  s_cmp_lg_u32 s3, 0
  s_cbranch_scc1 nh_sequen_18
  ds_read_b32 v96, v39 offset:0
  ds_read_b32 v97, v39 offset:128
  ds_read_b32 v98, v39 offset:256
  ds_read_b32 v99, v39 offset:384
  ds_read_b32 v100, v39 offset:512
  ds_read_b32 v101, v39 offset:640
  ds_read_b32 v102, v39 offset:768
  ds_read_b32 v103, v39 offset:896
  s_waitcnt lgkmcnt(4)
  v_add_f32 v96, v96, v97
  v_add_f32 v98, v98, v99
  s_waitcnt lgkmcnt(0)
  v_add_f32 v100, v100, v101
  v_add_f32 v102, v102, v103
  v_add_f32 v96, v96, v98
  v_add_f32 v100, v100, v102
  v_add_f32 v88, v96, v100
  v_lshlrev_b32 v89, 16, v42
  v_cvt_pk_bf16_f32 v88, v88, v88
  v_lshlrev_b32 v88, 16, v88
  v_add_f32 v88, v88, v89
  v_cvt_pk_bf16_f32 v88, v88, v88
  v_lshlrev_b32 v88, 16, v88
  v_or_b32 v89, s78, v88
  v_cmp_gt_u32 vcc, 32, v1
  s_and_saveexec_b64 s[82:83], vcc
  buffer_store_dword v89, v41, s[44:47], s16 offen sc1
  s_mov_b64 exec, s[82:83]
nh_sequen_18:
  s_mov_b32 s84, 20000
  s_mov_b64 s[82:83], exec
poll_sequen_19:
  buffer_load_dwordx4 v[72:75], v36, s[44:47], s17 offen sc1
  buffer_load_dwordx4 v[76:79], v37, s[44:47], s17 offen sc1
  s_waitcnt vmcnt(0)
  v_bitop3_b32 v12, v72, v73, v74 bitop3:0x80
  v_or3_b32 v13, v72, v73, v74
  v_bitop3_b32 v12, v12, v75, v76 bitop3:0x80
  v_or3_b32 v13, v13, v75, v76
  v_bitop3_b32 v12, v12, v77, v78 bitop3:0x80
  v_or3_b32 v13, v13, v77, v78
  v_and_b32 v12, v12, v79
  v_or_b32 v13, v13, v79
  v_xor_b32 v12, s77, v12
  v_xor_b32 v13, s77, v13
  v_or_b32 v12, v12, v13
  v_and_b32 v12, 1023, v12
  v_cmp_ne_u32 vcc, 0, v12
  s_and_b64 exec, exec, vcc
  s_cbranch_execz pdn_sequen_20
  s_sub_u32 s84, s84, 1
  s_cbranch_scc0 poll_sequen_19
pdn_sequen_20:
  s_mov_b64 exec, s[82:83]
  v_cmp_gt_u32 vcc, 48, v1
  s_nop 1
  v_cndmask_b32 v24, 0, v76, vcc
  v_cndmask_b32 v25, 0, v77, vcc
  v_cndmask_b32 v26, 0, v78, vcc
  v_cndmask_b32 v27, 0, v79, vcc
  v_and_b32 v20, v235, v72
  v_and_b32 v28, v235, v24
  v_and_b32 v21, v235, v73
  v_and_b32 v29, v235, v25
  v_and_b32 v22, v235, v74
  v_and_b32 v30, v235, v26
  v_and_b32 v23, v235, v75
  v_and_b32 v31, v235, v27
  v_add_f32 v20, v20, v28
  v_add_f32 v21, v21, v29
  v_add_f32 v22, v22, v30
  v_add_f32 v23, v23, v31
  s_nop 0
  v_permlane32_swap_b32 v20, v21
  v_permlane32_swap_b32 v22, v23
  v_add_f32 v20, v20, v21
  v_add_f32 v22, v22, v23
  s_nop 1
  v_permlane16_swap_b32 v20, v22
  v_add_f32 v20, v20, v22
  s_nop 1
  v_add_f32_dpp v20, v20, v20 row_ror:8 row_mask:0xf bank_mask:0xf
  ds_write_b32 v38, v20 offset:1024
  s_waitcnt lgkmcnt(0)
  s_barrier
  s_cmp_lg_u32 s3, 0
  s_cbranch_scc1 fin_sequen_10
  ds_read_b32 v96, v39 offset:1024
  ds_read_b32 v97, v39 offset:1152
  ds_read_b32 v98, v39 offset:1280
  ds_read_b32 v99, v39 offset:1408
  ds_read_b32 v100, v39 offset:1536
  ds_read_b32 v101, v39 offset:1664
  ds_read_b32 v102, v39 offset:1792
  ds_read_b32 v103, v39 offset:1920
  s_waitcnt lgkmcnt(4)
  v_add_f32 v96, v96, v97
  v_add_f32 v98, v98, v99
  s_waitcnt lgkmcnt(0)
  v_add_f32 v100, v100, v101
  v_add_f32 v102, v102, v103
  v_add_f32 v96, v96, v98
  v_add_f32 v100, v100, v102
  v_add_f32 v90, v96, v100
  v_cvt_pk_bf16_f32 v90, v90, v90
  v_lshlrev_b32 v90, 16, v90
  v_add_f32 v90, v90, v88
  v_cvt_pk_bf16_f32 v90, v90, v90
  v_cmp_gt_u32 vcc, 32, v1
  s_and_saveexec_b64 s[82:83], vcc
  buffer_store_short v90, v40, s[32:35], 0 offen
  s_cmp_lg_u32 s87, 0
  s_cbranch_scc1 fin_sequen_10
  s_mov_b64 exec, 1
  v_mov_b32 v12, s79
  v_mov_b32 v13, 0
  buffer_store_dword v12, v13, s[44:47], 0 offen offset:0
  s_branch fin_sequen_10
ffn_sequen_9:
  s_lshl_b32 s65, s3, 12
  s_add_u32 s65, s65, 20480
  s_mov_b32 m0, s65
  s_add_u32 s65, s74, 0
  buffer_load_dwordx4 v228, s[48:51], s65 offen  lds
  s_lshl_b32 s65, s3, 12
  s_add_u32 s65, s65, 21504
  s_mov_b32 m0, s65
  s_add_u32 s65, s74, 114688
  buffer_load_dwordx4 v228, s[48:51], s65 offen  lds
  s_lshl_b32 s65, s3, 12
  s_add_u32 s65, s65, 22528
  s_mov_b32 m0, s65
  s_add_u32 s65, s74, 0
  buffer_load_dwordx4 v228, s[52:55], s65 offen  lds
  s_lshl_b32 s65, s3, 12
  s_add_u32 s65, s65, 23552
  s_mov_b32 m0, s65
  s_add_u32 s65, s74, 114688
  buffer_load_dwordx4 v228, s[52:55], s65 offen  lds
  s_lshl_b32 s65, s3, 11
  s_add_u32 s65, s65, 53248
  s_mov_b32 m0, s65
  s_add_u32 s65, s75, 0
  buffer_load_dwordx4 v2, s[56:59], s65 offen  lds
  s_lshl_b32 s65, s3, 11
  s_add_u32 s65, s65, 54272
  s_mov_b32 m0, s65
  s_add_u32 s65, s75, 1024
  buffer_load_dwordx4 v2, s[56:59], s65 offen  lds
  s_cmp_ge_u32 s3, 2
  s_cbranch_scc1 nw_sequen_21
  s_mov_b32 s84, 20000
  s_mov_b64 s[82:83], exec
poll_sequen_23:
  buffer_load_dwordx4 v[88:91], v2, s[44:47], s12 offen sc1
  buffer_load_dwordx4 v[92:95], v2, s[44:47], s13 offen sc1
  s_waitcnt vmcnt(0)
  v_bitop3_b32 v12, v88, v89, v90 bitop3:0x80
  v_or3_b32 v13, v88, v89, v90
  v_bitop3_b32 v12, v12, v91, v92 bitop3:0x80
  v_or3_b32 v13, v13, v91, v92
  v_bitop3_b32 v12, v12, v93, v94 bitop3:0x80
  v_or3_b32 v13, v13, v93, v94
  v_and_b32 v12, v12, v95
  v_or_b32 v13, v13, v95
  v_xor_b32 v12, s78, v12
  v_xor_b32 v13, s78, v13
  v_or_b32 v12, v12, v13
  v_and_b32 v12, 65535, v12
  v_cmp_ne_u32 vcc, 0, v12
  s_and_b64 exec, exec, vcc
  s_cbranch_execz pdn_sequen_24
  s_sub_u32 s84, s84, 1
  s_cbranch_scc0 poll_sequen_23
pdn_sequen_24:
  s_mov_b64 exec, s[82:83]
  ds_read_b64_tr_b16 v[64:65], v35 offset:0
  ds_read_b64_tr_b16 v[66:67], v35 offset:128
  ds_read_b64_tr_b16 v[68:69], v35 offset:1024
  ds_read_b64_tr_b16 v[70:71], v35 offset:1152
  ds_read_b64_tr_b16 v[72:73], v35 offset:2048
  ds_read_b64_tr_b16 v[74:75], v35 offset:2176
  ds_read_b64_tr_b16 v[76:77], v35 offset:3072
  ds_read_b64_tr_b16 v[78:79], v35 offset:3200
  v_and_b32 v96, 0xffff0000, v88
  v_and_b32 v97, 0xffff0000, v89
  v_and_b32 v98, 0xffff0000, v90
  v_and_b32 v99, 0xffff0000, v91
  v_and_b32 v100, 0xffff0000, v92
  v_and_b32 v101, 0xffff0000, v93
  v_and_b32 v102, 0xffff0000, v94
  v_and_b32 v103, 0xffff0000, v95
  s_nop 0
  v_readfirstlane_b32 s65, v96
  s_nop 1
  v_subrev_f32 v24, s65, v96
  v_subrev_f32 v25, s65, v97
  v_subrev_f32 v26, s65, v98
  v_subrev_f32 v27, s65, v99
  v_subrev_f32 v28, s65, v100
  v_subrev_f32 v29, s65, v101
  v_subrev_f32 v30, s65, v102
  v_subrev_f32 v31, s65, v103
  v_add_f32 v20, v24, v25
  v_mul_f32 v21, v24, v24
  v_fmac_f32 v21, v25, v25
  v_add_f32 v20, v20, v26
  v_fmac_f32 v21, v26, v26
  v_add_f32 v20, v20, v27
  v_fmac_f32 v21, v27, v27
  v_add_f32 v20, v20, v28
  v_fmac_f32 v21, v28, v28
  v_add_f32 v20, v20, v29
  v_fmac_f32 v21, v29, v29
  v_add_f32 v20, v20, v30
  v_fmac_f32 v21, v30, v30
  v_add_f32 v20, v20, v31
  v_fmac_f32 v21, v31, v31
  s_nop 0
  v_add_f32_dpp v20, v20, v20 row_ror:8 row_mask:0xf bank_mask:0xf
  v_add_f32_dpp v21, v21, v21 row_ror:8 row_mask:0xf bank_mask:0xf
  s_nop 0
  v_add_f32_dpp v20, v20, v20 row_ror:4 row_mask:0xf bank_mask:0xf
  v_add_f32_dpp v21, v21, v21 row_ror:4 row_mask:0xf bank_mask:0xf
  s_nop 0
  v_add_f32_dpp v20, v20, v20 row_ror:2 row_mask:0xf bank_mask:0xf
  v_add_f32_dpp v21, v21, v21 row_ror:2 row_mask:0xf bank_mask:0xf
  s_nop 0
  v_add_f32_dpp v20, v20, v20 row_ror:1 row_mask:0xf bank_mask:0xf
  v_add_f32_dpp v21, v21, v21 row_ror:1 row_mask:0xf bank_mask:0xf
  s_nop 0
  v_mov_b32 v22, v20
  v_mov_b32 v24, v21
  s_nop 0
  v_permlane16_swap_b32 v20, v22
  v_permlane16_swap_b32 v21, v24
  v_add_f32 v20, v20, v22
  v_add_f32 v21, v21, v24
  v_mov_b32 v22, v20
  v_mov_b32 v24, v21
  s_nop 0
  v_permlane32_swap_b32 v20, v22
  v_permlane32_swap_b32 v21, v24
  v_add_f32 v20, v20, v22
  v_add_f32 v21, v21, v24
  v_mul_f32 v20, 0x3b000000, v20
  v_mul_f32 v21, 0x3b000000, v21
  v_fma_f32 v21, -v20, v20, v21
  v_add_f32 v20, s65, v20
  v_max_f32 v21, 0, v21
  v_cvt_pk_bf16_f32 v21, v21, v20
  v_and_b32 v20, 0xffff0000, v21
  v_lshlrev_b32 v21, 16, v21
  v_add_f32 v21, 0x3727c5ac, v21
  v_cvt_pk_bf16_f32 v21, v21, v21
  v_lshlrev_b32 v21, 16, v21
  v_sqrt_f32 v21, v21
  s_nop 0
  v_cvt_pk_bf16_f32 v21, v21, v21
  v_lshlrev_b32 v21, 16, v21
  v_rcp_f32 v23, v21
  s_nop 0
  v_sub_f32 v96, v96, v20
  v_sub_f32 v97, v97, v20
  v_sub_f32 v98, v98, v20
  v_sub_f32 v99, v99, v20
  v_sub_f32 v100, v100, v20
  v_sub_f32 v101, v101, v20
  v_sub_f32 v102, v102, v20
  v_sub_f32 v103, v103, v20
  v_cvt_pk_bf16_f32 v96, v96, v97
  v_and_b32 v97, 0xffff0000, v96
  v_lshlrev_b32 v96, 16, v96
  v_cvt_pk_bf16_f32 v98, v98, v99
  v_and_b32 v99, 0xffff0000, v98
  v_lshlrev_b32 v98, 16, v98
  v_cvt_pk_bf16_f32 v100, v100, v101
  v_and_b32 v101, 0xffff0000, v100
  v_lshlrev_b32 v100, 16, v100
  v_cvt_pk_bf16_f32 v102, v102, v103
  v_and_b32 v103, 0xffff0000, v102
  v_lshlrev_b32 v102, 16, v102
  v_mul_f32 v96, v96, v23
  v_mul_f32 v97, v97, v23
  v_mul_f32 v98, v98, v23
  v_mul_f32 v99, v99, v23
  v_mul_f32 v100, v100, v23
  v_mul_f32 v101, v101, v23
  v_mul_f32 v102, v102, v23
  v_mul_f32 v103, v103, v23
  v_cvt_pk_bf16_f32 v24, v96, v97
  v_cvt_pk_bf16_f32 v25, v98, v99
  v_cvt_pk_bf16_f32 v26, v100, v101
  v_cvt_pk_bf16_f32 v27, v102, v103
  ds_write_b64 v37, v[24:25]
  ds_write_b64 v37, v[26:27] offset:512
  s_branch jn_sequen_22
nw_sequen_21:
  s_waitcnt vmcnt(0)
  ds_read_b64_tr_b16 v[64:65], v35 offset:0
  ds_read_b64_tr_b16 v[66:67], v35 offset:128
  ds_read_b64_tr_b16 v[68:69], v35 offset:1024
  ds_read_b64_tr_b16 v[70:71], v35 offset:1152
  ds_read_b64_tr_b16 v[72:73], v35 offset:2048
  ds_read_b64_tr_b16 v[74:75], v35 offset:2176
  ds_read_b64_tr_b16 v[76:77], v35 offset:3072
  ds_read_b64_tr_b16 v[78:79], v35 offset:3200
jn_sequen_22:
  s_waitcnt lgkmcnt(0)
  s_barrier
  ds_read_b128 v[12:15], v38
  ds_read_b128 v[16:19], v38 offset:64
  ds_read_b128 v[80:83], v36
  ds_read_b128 v[84:87], v36 offset:4096
  s_waitcnt lgkmcnt(3)
  v_mfma_f32_16x16x32_bf16 v[216:219], v[12:15], v[64:67], 0
  v_mfma_f32_16x16x32_bf16 v[220:223], v[12:15], v[72:75], 0
  s_waitcnt lgkmcnt(2)
  v_mfma_f32_16x16x32_bf16 v[216:219], v[16:19], v[68:71], v[216:219]
  v_mfma_f32_16x16x32_bf16 v[220:223], v[16:19], v[76:79], v[220:223]
  v_cmp_gt_u32 vcc, 16, v1
  s_nop 6
  s_and_saveexec_b64 s[82:83], vcc
  ds_write2_b32 v39, v216, v220 offset0:0 offset1:1
  ds_write2_b32 v39, v217, v221 offset0:16 offset1:17
  s_mov_b64 exec, s[82:83]
  s_waitcnt lgkmcnt(0)
  s_barrier
  ds_read_b128 v[96:99], v40 offset:0
  ds_read_b128 v[100:103], v40 offset:16
  ds_read_b128 v[104:107], v40 offset:32
  ds_read_b128 v[108:111], v40 offset:48
  ds_read_b128 v[112:115], v40 offset:576
  ds_read_b128 v[116:119], v40 offset:592
  ds_read_b128 v[120:123], v40 offset:608
  ds_read_b128 v[124:127], v40 offset:624
  s_waitcnt lgkmcnt(4)
  v_add_f32 v96, v96, v98
  v_add_f32 v100, v100, v102
  v_add_f32 v104, v104, v106
  v_add_f32 v108, v108, v110
  v_add_f32 v97, v97, v99
  v_add_f32 v101, v101, v103
  v_add_f32 v105, v105, v107
  v_add_f32 v109, v109, v111
  v_add_f32 v96, v96, v100
  v_add_f32 v104, v104, v108
  v_add_f32 v97, v97, v101
  v_add_f32 v105, v105, v109
  v_add_f32 v96, v96, v104
  v_add_f32 v97, v97, v105
  s_waitcnt lgkmcnt(0)
  v_add_f32 v112, v112, v114
  v_add_f32 v116, v116, v118
  v_add_f32 v120, v120, v122
  v_add_f32 v124, v124, v126
  v_add_f32 v113, v113, v115
  v_add_f32 v117, v117, v119
  v_add_f32 v121, v121, v123
  v_add_f32 v125, v125, v127
  v_add_f32 v112, v112, v116
  v_add_f32 v120, v120, v124
  v_add_f32 v113, v113, v117
  v_add_f32 v121, v121, v125
  v_add_f32 v112, v112, v120
  v_add_f32 v113, v113, v121
  v_cvt_pk_bf16_f32 v96, v96, v97
  v_cvt_pk_bf16_f32 v112, v112, v113
  v_and_b32 v97, 0xffff0000, v96
  v_lshlrev_b32 v96, 16, v96
  v_and_b32 v113, 0xffff0000, v112
  v_lshlrev_b32 v112, 16, v112
  v_mul_f32 v98, 0xbfb8aa3b, v96
  v_mul_f32 v114, 0xbfb8aa3b, v112
  v_exp_f32 v98, v98
  v_exp_f32 v114, v114
  s_nop 0
  v_add_f32 v98, 1.0, v98
  v_add_f32 v114, 1.0, v114
  v_rcp_f32 v99, v98
  v_rcp_f32 v115, v114
  s_nop 0
  v_mul_f32 v100, v96, v99
  v_mul_f32 v116, v112, v115
  v_fma_f32 v101, -v100, v98, v96
  v_fma_f32 v117, -v116, v114, v112
  v_fma_f32 v100, v101, v99, v100
  v_fma_f32 v116, v117, v115, v116
  v_cvt_pk_bf16_f32 v100, v100, v100
  v_cvt_pk_bf16_f32 v116, v116, v116
  v_lshlrev_b32 v100, 16, v100
  v_lshlrev_b32 v116, 16, v116
  v_mul_f32 v100, v100, v97
  v_mul_f32 v116, v116, v113
  v_cvt_pk_bf16_f32 v100, v100, v100
  v_cvt_pk_bf16_f32 v116, v116, v116
  v_and_b32 v200, v100, v196
  v_and_b32 v201, v100, v197
  v_and_b32 v202, v100, v198
  v_and_b32 v203, v100, v199
  v_and_b32 v204, v116, v196
  v_and_b32 v205, v116, v197
  v_and_b32 v206, v116, v198
  v_and_b32 v207, v116, v199
  s_nop 0
  v_mfma_f32_16x16x32_bf16 v[216:219], v[200:203], v[80:83], 0
  s_nop 0
  v_mfma_f32_16x16x32_bf16 v[216:219], v[204:207], v[84:87], v[216:219]
  s_nop 7
  ds_write_b128 v41, v[216:219]
  s_waitcnt lgkmcnt(0)
  s_barrier
  s_cmp_ge_u32 s3, 4
  s_cbranch_scc1 fin_sequen_10
  ds_read_b128 v[12:15], v42
  ds_read_b128 v[16:19], v42 offset:4096
  s_waitcnt lgkmcnt(0)
  v_add_f32 v12, v12, v16
  v_add_f32 v13, v13, v17
  v_add_f32 v14, v14, v18
  v_add_f32 v15, v15, v19
  v_and_or_b32 v12, v12, v235, s77
  v_and_or_b32 v13, v13, v235, s77
  v_and_or_b32 v14, v14, v235, s77
  v_and_or_b32 v15, v15, v235, s77
  buffer_store_dwordx4 v[12:15], v236, s[44:47], s16 offen sc1
fin_sequen_10:
end_sequen_1:
  s_endpgm

.section .rodata,"a"
.p2align 6
.amdhsa_kernel sequential_preLN__mha_block_cached__swiglu_ffn__decode_kernel
  .amdhsa_next_free_vgpr 240
  .amdhsa_next_free_sgpr 102
  .amdhsa_accum_offset 240
  .amdhsa_group_segment_fixed_size 0
  .amdhsa_kernarg_size 96
  .amdhsa_user_sgpr_count 2
  .amdhsa_user_sgpr_kernarg_segment_ptr 1
  .amdhsa_system_sgpr_workgroup_id_x 1
  .amdhsa_float_denorm_mode_32 3
.end_amdhsa_kernel
```
